```python
import torch

def _softmax(x, axis=-1):
    return torch.softmax(x, dim=axis)
def _gelu(x):
    return torch.nn.functional.gelu(x, approximate="tanh")
def _silu(x):
    return torch.nn.functional.silu(x)
def _sigmoid(x):
    return torch.sigmoid(x)
def _layernorm(x, axis=-1, eps=1e-5):
    m = x.mean(dim=axis, keepdim=True)
    v = x.var(dim=axis, keepdim=True, unbiased=False)
    return (x - m) / torch.sqrt(v + eps)
def _scatter_add(tgt, idx, src, axis=0):
    return tgt.clone().index_add_(axis, idx, src)
def _segment_sum(src, seg, n):
    out = torch.zeros((n,) + src.shape[1:], dtype=src.dtype)
    return out.index_add_(0, seg, src)
def _pad(x, pw):
    flat = tuple(v for pair in reversed(pw) for v in pair)
    return torch.nn.functional.pad(x, flat)

kernel_name = 'standalone__cheap_equivariant_egnn__graph'

def setup_inputs():

    _w = (lambda a: (lambda t: t.to(torch.bfloat16) if t.is_floating_point() else t)(torch.as_tensor(a)))
    N, deg, D, De = 12500, 32, 128, max(4, 1)
    E = N * deg
    return {
        "h": _w((lambda *s: torch.randn(*s, dtype=torch.bfloat16) * 0.1)(N, D)),
        "pos": _w((lambda *s: torch.randn(*s, dtype=torch.bfloat16) * 0.8)(N, 3)),
        "e_attr": _w((lambda *s: torch.randn(*s, dtype=torch.bfloat16) * 0.8)(E, De)),
        "src": _w((lambda lo, hi, *s: torch.randint(lo, hi, s))(0, N, E).to(torch.int64)),
        "dst": _w((lambda lo, hi, *s: torch.randint(lo, hi, s))(0, N, E).to(torch.int64)),
        "w_e": _w(0.1 * (lambda *s: torch.randn(*s, dtype=torch.bfloat16) * 0.8)(2 * D + 1 + De, D)),
        "w_x": _w(0.1 * (lambda *s: torch.randn(*s, dtype=torch.bfloat16) * 0.1)(D, 1)),
        "w_h": _w(0.1 * (lambda *s: torch.randn(*s, dtype=torch.bfloat16) * 0.1)(2 * D, D)),
    }

def reference(h, pos, e_attr, src, dst, w_e, w_x, w_h):
    N, D = h.shape[0], h.shape[1]
    diff = pos[dst] - pos[src]
    dist2 = torch.sum(diff * diff, axis=-1, keepdims=True)
    e_in = torch.concatenate([h[dst], h[src], dist2, e_attr], axis=-1)
    m_ij = _silu(e_in @ w_e)
    coord_scale = m_ij @ w_x
    pos_new = pos + _segment_sum(diff * coord_scale, dst, N)
    m_i = _segment_sum(m_ij, dst, N)
    h_new = h + _silu(torch.concatenate([h, m_i], axis=-1) @ w_h)
    return h_new, pos_new
```

```asm
; @launch kernel=egnn_prep_kernel grid=(501,1,1) block=(512,1,1) lds=81920
; @launch kernel=standalone__cheap_equivariant_egnn__graph_kernel grid=(250,1,1) block=(512,1,1) lds=163840
.amdgcn_target "amdgcn-amd-amdhsa--gfx950"
.text
.globl egnn_prep_kernel
.p2align 8
.type egnn_prep_kernel,@function
egnn_prep_kernel:
  s_cmp_ge_u32 s2, 501
  s_cbranch_scc1 K1_EXIT
  s_load_dwordx2 s[4:5], s[0:1], 0
  s_load_dwordx2 s[6:7], s[0:1], 8
  s_load_dwordx2 s[8:9], s[0:1], 16
  s_load_dwordx2 s[10:11], s[0:1], 24
  s_load_dwordx2 s[12:13], s[0:1], 32
  s_load_dwordx2 s[14:15], s[0:1], 40
  s_load_dwordx2 s[16:17], s[0:1], 56
  s_load_dwordx2 s[18:19], s[0:1], 80
  v_and_b32 v1, 63, v0
  v_lshrrev_b32 v2, 6, v0
  s_nop 0
  v_readfirstlane_b32 s60, v2
  s_waitcnt lgkmcnt(0)
  s_mov_b32 s20, s4
  s_mov_b32 s21, s5
  s_mov_b32 s22, 3200000
  s_mov_b32 s23, 0x00020000
  s_mov_b32 s24, s6
  s_mov_b32 s25, s7
  s_mov_b32 s26, 75000
  s_mov_b32 s27, 0x00020000
  s_mov_b32 s28, s8
  s_mov_b32 s29, s9
  s_mov_b32 s30, 3200000
  s_mov_b32 s31, 0x00020000
  s_mov_b32 s32, s10
  s_mov_b32 s33, s11
  s_mov_b32 s34, 1600000
  s_mov_b32 s35, 0x00020000
  s_mov_b32 s36, s12
  s_mov_b32 s37, s13
  s_mov_b32 s38, 1600000
  s_mov_b32 s39, 0x00020000
  s_mov_b32 s40, s14
  s_mov_b32 s41, s15
  s_mov_b32 s42, 66816
  s_mov_b32 s43, 0x00020000
  s_mov_b32 s44, s16
  s_mov_b32 s45, s17
  s_mov_b32 s46, 65536
  s_mov_b32 s47, 0x00020000
  s_mov_b32 s48, s18
  s_mov_b32 s49, s19
  s_mov_b32 s50, 268435456
  s_mov_b32 s51, 0x00020000
  s_cmp_lt_u32 s2, 250
  s_cbranch_scc1 K1_PART
  s_cmp_lt_u32 s2, 500
  s_cbranch_scc1 K1_GEMM
  s_branch K1_WPREP
K1_PART:
  s_mul_i32 s61, s2, 1600
  v_lshlrev_b32 v3, 2, v0
  v_lshlrev_b32 v4, 4, v0
  v_lshlrev_b32 v5, 5, v0
  v_mov_b32 v6, 0
  s_movk_i32 s70, 400
  v_cmp_gt_u32 s[64:65], s70, v0
  s_lshl_b32 s66, s61, 2
  s_lshl_b32 s67, s61, 3
  s_mov_b64 exec, s[64:65]
  buffer_load_dwordx4 v[8:11], v4, s[36:39], s66 offen
  buffer_load_dwordx4 v[12:15], v4, s[32:35], s66 offen
  buffer_load_dwordx4 v[16:19], v5, s[28:31], s67 offen
  buffer_load_dwordx4 v[20:23], v5, s[28:31], s67 offen offset:16
  s_mov_b64 exec, -1
  v_lshlrev_b32 v7, 4, v1
  s_lshl_b32 s68, s60, 10
  s_add_u32 s69, s68, 0
  s_add_u32 m0, s69, 2048
  s_nop 0
  buffer_load_dwordx4 v7, s[24:27], s69 offen lds
  s_add_u32 s69, s68, 8192
  s_add_u32 m0, s69, 2048
  s_nop 0
  buffer_load_dwordx4 v7, s[24:27], s69 offen lds
  s_add_u32 s69, s68, 16384
  s_add_u32 m0, s69, 2048
  s_nop 0
  buffer_load_dwordx4 v7, s[24:27], s69 offen lds
  s_add_u32 s69, s68, 24576
  s_add_u32 m0, s69, 2048
  s_nop 0
  buffer_load_dwordx4 v7, s[24:27], s69 offen lds
  s_add_u32 s69, s68, 32768
  s_add_u32 m0, s69, 2048
  s_nop 0
  buffer_load_dwordx4 v7, s[24:27], s69 offen lds
  s_add_u32 s69, s68, 40960
  s_add_u32 m0, s69, 2048
  s_nop 0
  buffer_load_dwordx4 v7, s[24:27], s69 offen lds
  s_add_u32 s69, s68, 49152
  s_add_u32 m0, s69, 2048
  s_nop 0
  buffer_load_dwordx4 v7, s[24:27], s69 offen lds
  s_add_u32 s69, s68, 57344
  s_add_u32 m0, s69, 2048
  s_nop 0
  buffer_load_dwordx4 v7, s[24:27], s69 offen lds
  s_add_u32 s69, s68, 65536
  s_add_u32 m0, s69, 2048
  s_nop 0
  buffer_load_dwordx4 v7, s[24:27], s69 offen lds
  s_cmp_ge_u32 s60, 2
  s_cbranch_scc1 K1_pd_10
  s_add_u32 s69, s68, 73728
  s_add_u32 m0, s69, 2048
  s_nop 0
  buffer_load_dwordx4 v7, s[24:27], s69 offen lds
K1_pd_10:
  v_cmp_gt_u32 vcc, 256, v0
  s_nop 1
  s_and_saveexec_b64 s[62:63], vcc
  ds_write_b32 v3, v6 offset:0
  s_mov_b64 exec, s[62:63]
  s_waitcnt lgkmcnt(0)
  s_barrier
  s_mov_b64 exec, s[64:65]
  v_mov_b32 v6, 1
  s_cmp_lt_u32 s60, 2
  s_cselect_b32 s71, 13, 12
  s_waitcnt vmcnt(12)
  v_mul_u32_u24 v7, 5243, v8
  v_lshrrev_b32 v24, 18, v7
  v_mul_u32_u24 v7, 50, v24
  v_sub_u32 v28, v8, v7
  v_lshlrev_b32 v7, 2, v24
  ds_add_rtn_u32 v32, v7, v6 offset:0
  v_mul_u32_u24 v7, 5243, v9
  v_lshrrev_b32 v25, 18, v7
  v_mul_u32_u24 v7, 50, v25
  v_sub_u32 v29, v9, v7
  v_lshlrev_b32 v7, 2, v25
  ds_add_rtn_u32 v33, v7, v6 offset:0
  v_mul_u32_u24 v7, 5243, v10
  v_lshrrev_b32 v26, 18, v7
  v_mul_u32_u24 v7, 50, v26
  v_sub_u32 v30, v10, v7
  v_lshlrev_b32 v7, 2, v26
  ds_add_rtn_u32 v34, v7, v6 offset:0
  v_mul_u32_u24 v7, 5243, v11
  v_lshrrev_b32 v27, 18, v7
  v_mul_u32_u24 v7, 50, v27
  v_sub_u32 v31, v11, v7
  v_lshlrev_b32 v7, 2, v27
  ds_add_rtn_u32 v35, v7, v6 offset:0
  s_mov_b64 exec, -1
  s_waitcnt vmcnt(0) lgkmcnt(0)
  s_barrier
  s_mov_b64 exec, s[64:65]
  v_mov_b32 v116, 2048
  v_mad_u32_u24 v7, v8, 6, v116
  v_and_b32 v7, 0xfffffffc, v7
  ds_read2_b32 v[36:37], v7 offset1:1
  v_mad_u32_u24 v7, v12, 6, v116
  v_and_b32 v7, 0xfffffffc, v7
  ds_read2_b32 v[44:45], v7 offset1:1
  v_mad_u32_u24 v7, v9, 6, v116
  v_and_b32 v7, 0xfffffffc, v7
  ds_read2_b32 v[38:39], v7 offset1:1
  v_mad_u32_u24 v7, v13, 6, v116
  v_and_b32 v7, 0xfffffffc, v7
  ds_read2_b32 v[46:47], v7 offset1:1
  v_mad_u32_u24 v7, v10, 6, v116
  v_and_b32 v7, 0xfffffffc, v7
  ds_read2_b32 v[40:41], v7 offset1:1
  v_mad_u32_u24 v7, v14, 6, v116
  v_and_b32 v7, 0xfffffffc, v7
  ds_read2_b32 v[48:49], v7 offset1:1
  v_mad_u32_u24 v7, v11, 6, v116
  v_and_b32 v7, 0xfffffffc, v7
  ds_read2_b32 v[42:43], v7 offset1:1
  v_mad_u32_u24 v7, v15, 6, v116
  v_and_b32 v7, 0xfffffffc, v7
  ds_read2_b32 v[50:51], v7 offset1:1
  s_mov_b64 exec, -1
  s_cmp_lg_u32 s60, 0
  s_cbranch_scc1 K1_SCANDONE
  v_lshlrev_b32 v100, 4, v1
  ds_read_b128 v[104:107], v100 offset:0
  s_waitcnt lgkmcnt(0)
  v_add_u32 v108, v104, v105
  v_add_u32 v109, v108, v106
  v_add_u32 v110, v109, v107
  v_mov_b32 v111, v110
  s_nop 1
  v_add_u32_dpp v111, v111, v111 row_shr:1 row_mask:0xf bank_mask:0xf bound_ctrl:0
  s_nop 1
  v_add_u32_dpp v111, v111, v111 row_shr:2 row_mask:0xf bank_mask:0xf bound_ctrl:0
  s_nop 1
  v_add_u32_dpp v111, v111, v111 row_shr:4 row_mask:0xf bank_mask:0xf bound_ctrl:0
  s_nop 1
  v_add_u32_dpp v111, v111, v111 row_shr:8 row_mask:0xf bank_mask:0xf bound_ctrl:0
  s_nop 1
  v_add_u32_dpp v111, v111, v111 row_bcast:15 row_mask:0xa bank_mask:0xf
  s_nop 1
  v_add_u32_dpp v111, v111, v111 row_bcast:31 row_mask:0xc bank_mask:0xf
  v_sub_u32 v112, v111, v110
  v_add_u32 v113, v112, v104
  v_add_u32 v114, v112, v108
  v_add_u32 v115, v112, v109
  ds_write_b128 v100, v[112:115] offset:1024
K1_SCANDONE:
  s_waitcnt lgkmcnt(0)
  s_barrier
  v_cmp_gt_u32 vcc, 250, v0
  s_nop 1
  s_and_saveexec_b64 s[62:63], vcc
  s_cbranch_execz K1_NOTAB
  ds_read_b32 v100, v3 offset:0
  ds_read_b32 v101, v3 offset:1024
  v_lshlrev_b32 v102, 10, v0
  s_lshl_b32 s68, s2, 2
  s_add_u32 s68, s68, 14784000
  s_waitcnt lgkmcnt(0)
  v_lshl_or_b32 v100, v100, 16, v101
  buffer_store_dword v100, v102, s[48:51], s68 offen
K1_NOTAB:
  s_mov_b64 exec, s[64:65]
  v_lshlrev_b32 v7, 2, v24
  ds_read_b32 v24, v7 offset:1024
  v_lshlrev_b32 v7, 2, v25
  ds_read_b32 v25, v7 offset:1024
  v_lshlrev_b32 v7, 2, v26
  ds_read_b32 v26, v7 offset:1024
  v_lshlrev_b32 v7, 2, v27
  ds_read_b32 v27, v7 offset:1024
  s_mov_b32 s70, 0xbfb8aa3b
  s_waitcnt lgkmcnt(0)
  v_add_u32 v32, v24, v32
  v_and_b32 v7, 1, v8
  v_lshlrev_b32 v7, 4, v7
  v_lshrrev_b64 v[36:37], v7, v[36:37]
  v_and_b32 v7, 1, v12
  v_lshlrev_b32 v7, 4, v7
  v_lshrrev_b64 v[44:45], v7, v[44:45]
  v_lshlrev_b32 v100, 16, v36
  v_and_b32 v101, 0xffff0000, v36
  v_lshlrev_b32 v102, 16, v37
  v_lshlrev_b32 v103, 16, v44
  v_and_b32 v104, 0xffff0000, v44
  v_lshlrev_b32 v105, 16, v45
  v_sub_f32 v100, v100, v103
  v_sub_f32 v101, v101, v104
  v_sub_f32 v102, v102, v105
  v_cvt_pk_bf16_f32 v111, v101, v102
  v_cvt_pk_bf16_f32 v103, v100, v100
  v_lshlrev_b32 v100, 16, v103
  v_lshlrev_b32 v101, 16, v111
  v_and_b32 v102, 0xffff0000, v111
  v_mul_f32 v103, v100, v100
  v_mul_f32 v104, v101, v101
  v_mul_f32 v105, v102, v102
  v_cvt_pk_bf16_f32 v103, v103, v104
  v_cvt_pk_bf16_f32 v105, v105, v105
  v_lshlrev_b32 v104, 16, v103
  v_and_b32 v103, 0xffff0000, v103
  v_lshlrev_b32 v105, 16, v105
  v_add_f32 v103, v104, v103
  v_add_f32 v103, v103, v105
  v_cvt_pk_bf16_f32 v103, v103, v103
  v_lshlrev_b32 v103, 16, v103
  v_mul_f32 v103, s70, v103
  v_cvt_pk_bf16_f32 v110, v103, v100
  v_lshlrev_b32 v103, 16, v16
  v_and_b32 v104, 0xffff0000, v16
  v_lshlrev_b32 v105, 16, v17
  v_and_b32 v106, 0xffff0000, v17
  v_mul_f32 v103, s70, v103
  v_mul_f32 v104, s70, v104
  v_mul_f32 v105, s70, v105
  v_mul_f32 v106, s70, v106
  v_cvt_pk_bf16_f32 v108, v103, v104
  v_cvt_pk_bf16_f32 v109, v105, v106
  v_lshlrev_b32 v7, 4, v32
  ds_write_b128 v7, v[108:111] offset:2048
  v_lshl_or_b32 v106, v12, 8, v28
  v_lshlrev_b32 v7, 2, v32
  ds_write_b32 v7, v106 offset:27648
  v_add_u32 v33, v25, v33
  v_and_b32 v7, 1, v9
  v_lshlrev_b32 v7, 4, v7
  v_lshrrev_b64 v[38:39], v7, v[38:39]
  v_and_b32 v7, 1, v13
  v_lshlrev_b32 v7, 4, v7
  v_lshrrev_b64 v[46:47], v7, v[46:47]
  v_lshlrev_b32 v100, 16, v38
  v_and_b32 v101, 0xffff0000, v38
  v_lshlrev_b32 v102, 16, v39
  v_lshlrev_b32 v103, 16, v46
  v_and_b32 v104, 0xffff0000, v46
  v_lshlrev_b32 v105, 16, v47
  v_sub_f32 v100, v100, v103
  v_sub_f32 v101, v101, v104
  v_sub_f32 v102, v102, v105
  v_cvt_pk_bf16_f32 v111, v101, v102
  v_cvt_pk_bf16_f32 v103, v100, v100
  v_lshlrev_b32 v100, 16, v103
  v_lshlrev_b32 v101, 16, v111
  v_and_b32 v102, 0xffff0000, v111
  v_mul_f32 v103, v100, v100
  v_mul_f32 v104, v101, v101
  v_mul_f32 v105, v102, v102
  v_cvt_pk_bf16_f32 v103, v103, v104
  v_cvt_pk_bf16_f32 v105, v105, v105
  v_lshlrev_b32 v104, 16, v103
  v_and_b32 v103, 0xffff0000, v103
  v_lshlrev_b32 v105, 16, v105
  v_add_f32 v103, v104, v103
  v_add_f32 v103, v103, v105
  v_cvt_pk_bf16_f32 v103, v103, v103
  v_lshlrev_b32 v103, 16, v103
  v_mul_f32 v103, s70, v103
  v_cvt_pk_bf16_f32 v110, v103, v100
  v_lshlrev_b32 v103, 16, v18
  v_and_b32 v104, 0xffff0000, v18
  v_lshlrev_b32 v105, 16, v19
  v_and_b32 v106, 0xffff0000, v19
  v_mul_f32 v103, s70, v103
  v_mul_f32 v104, s70, v104
  v_mul_f32 v105, s70, v105
  v_mul_f32 v106, s70, v106
  v_cvt_pk_bf16_f32 v108, v103, v104
  v_cvt_pk_bf16_f32 v109, v105, v106
  v_lshlrev_b32 v7, 4, v33
  ds_write_b128 v7, v[108:111] offset:2048
  v_lshl_or_b32 v106, v13, 8, v29
  v_lshlrev_b32 v7, 2, v33
  ds_write_b32 v7, v106 offset:27648
  v_add_u32 v34, v26, v34
  v_and_b32 v7, 1, v10
  v_lshlrev_b32 v7, 4, v7
  v_lshrrev_b64 v[40:41], v7, v[40:41]
  v_and_b32 v7, 1, v14
  v_lshlrev_b32 v7, 4, v7
  v_lshrrev_b64 v[48:49], v7, v[48:49]
  v_lshlrev_b32 v100, 16, v40
  v_and_b32 v101, 0xffff0000, v40
  v_lshlrev_b32 v102, 16, v41
  v_lshlrev_b32 v103, 16, v48
  v_and_b32 v104, 0xffff0000, v48
  v_lshlrev_b32 v105, 16, v49
  v_sub_f32 v100, v100, v103
  v_sub_f32 v101, v101, v104
  v_sub_f32 v102, v102, v105
  v_cvt_pk_bf16_f32 v111, v101, v102
  v_cvt_pk_bf16_f32 v103, v100, v100
  v_lshlrev_b32 v100, 16, v103
  v_lshlrev_b32 v101, 16, v111
  v_and_b32 v102, 0xffff0000, v111
  v_mul_f32 v103, v100, v100
  v_mul_f32 v104, v101, v101
  v_mul_f32 v105, v102, v102
  v_cvt_pk_bf16_f32 v103, v103, v104
  v_cvt_pk_bf16_f32 v105, v105, v105
  v_lshlrev_b32 v104, 16, v103
  v_and_b32 v103, 0xffff0000, v103
  v_lshlrev_b32 v105, 16, v105
  v_add_f32 v103, v104, v103
  v_add_f32 v103, v103, v105
  v_cvt_pk_bf16_f32 v103, v103, v103
  v_lshlrev_b32 v103, 16, v103
  v_mul_f32 v103, s70, v103
  v_cvt_pk_bf16_f32 v110, v103, v100
  v_lshlrev_b32 v103, 16, v20
  v_and_b32 v104, 0xffff0000, v20
  v_lshlrev_b32 v105, 16, v21
  v_and_b32 v106, 0xffff0000, v21
  v_mul_f32 v103, s70, v103
  v_mul_f32 v104, s70, v104
  v_mul_f32 v105, s70, v105
  v_mul_f32 v106, s70, v106
  v_cvt_pk_bf16_f32 v108, v103, v104
  v_cvt_pk_bf16_f32 v109, v105, v106
  v_lshlrev_b32 v7, 4, v34
  ds_write_b128 v7, v[108:111] offset:2048
  v_lshl_or_b32 v106, v14, 8, v30
  v_lshlrev_b32 v7, 2, v34
  ds_write_b32 v7, v106 offset:27648
  v_add_u32 v35, v27, v35
  v_and_b32 v7, 1, v11
  v_lshlrev_b32 v7, 4, v7
  v_lshrrev_b64 v[42:43], v7, v[42:43]
  v_and_b32 v7, 1, v15
  v_lshlrev_b32 v7, 4, v7
  v_lshrrev_b64 v[50:51], v7, v[50:51]
  v_lshlrev_b32 v100, 16, v42
  v_and_b32 v101, 0xffff0000, v42
  v_lshlrev_b32 v102, 16, v43
  v_lshlrev_b32 v103, 16, v50
  v_and_b32 v104, 0xffff0000, v50
  v_lshlrev_b32 v105, 16, v51
  v_sub_f32 v100, v100, v103
  v_sub_f32 v101, v101, v104
  v_sub_f32 v102, v102, v105
  v_cvt_pk_bf16_f32 v111, v101, v102
  v_cvt_pk_bf16_f32 v103, v100, v100
  v_lshlrev_b32 v100, 16, v103
  v_lshlrev_b32 v101, 16, v111
  v_and_b32 v102, 0xffff0000, v111
  v_mul_f32 v103, v100, v100
  v_mul_f32 v104, v101, v101
  v_mul_f32 v105, v102, v102
  v_cvt_pk_bf16_f32 v103, v103, v104
  v_cvt_pk_bf16_f32 v105, v105, v105
  v_lshlrev_b32 v104, 16, v103
  v_and_b32 v103, 0xffff0000, v103
  v_lshlrev_b32 v105, 16, v105
  v_add_f32 v103, v104, v103
  v_add_f32 v103, v103, v105
  v_cvt_pk_bf16_f32 v103, v103, v103
  v_lshlrev_b32 v103, 16, v103
  v_mul_f32 v103, s70, v103
  v_cvt_pk_bf16_f32 v110, v103, v100
  v_lshlrev_b32 v103, 16, v22
  v_and_b32 v104, 0xffff0000, v22
  v_lshlrev_b32 v105, 16, v23
  v_and_b32 v106, 0xffff0000, v23
  v_mul_f32 v103, s70, v103
  v_mul_f32 v104, s70, v104
  v_mul_f32 v105, s70, v105
  v_mul_f32 v106, s70, v106
  v_cvt_pk_bf16_f32 v108, v103, v104
  v_cvt_pk_bf16_f32 v109, v105, v106
  v_lshlrev_b32 v7, 4, v35
  ds_write_b128 v7, v[108:111] offset:2048
  v_lshl_or_b32 v106, v15, 8, v31
  v_lshlrev_b32 v7, 2, v35
  ds_write_b32 v7, v106 offset:27648
  s_mov_b64 exec, -1
  s_waitcnt lgkmcnt(0)
  s_barrier
  s_lshl_b32 s68, s61, 4
  s_add_u32 s68, s68, 6784000
  s_add_u32 s69, s66, 13184000
  ds_read_b128 v[8:11], v4 offset:2048
  ds_read_b128 v[12:15], v4 offset:10240
  ds_read_b128 v[16:19], v4 offset:18432
  ds_read_b128 v[20:23], v4 offset:26624
  ds_read_b128 v[24:27], v4 offset:27648
  s_waitcnt lgkmcnt(0)
  buffer_store_dwordx4 v[8:11], v4, s[48:51], s68 offen
  s_add_u32 s68, s68, 8192
  buffer_store_dwordx4 v[12:15], v4, s[48:51], s68 offen
  s_add_u32 s68, s68, 8192
  buffer_store_dwordx4 v[16:19], v4, s[48:51], s68 offen
  s_add_u32 s68, s68, 8192
  v_cmp_gt_u32 vcc, 64, v0
  s_nop 1
  s_mov_b64 exec, vcc
  buffer_store_dwordx4 v[20:23], v4, s[48:51], s68 offen
  s_mov_b64 exec, s[64:65]
  buffer_store_dwordx4 v[24:27], v4, s[48:51], s69 offen
  s_mov_b64 exec, -1
  s_branch K1_END
K1_GEMM:
  s_sub_u32 s61, s2, 250
  s_lshr_b32 s62, s60, 2
  s_and_b32 s63, s60, 3
  v_and_b32 v2, 31, v1
  v_lshrrev_b32 v3, 5, v1
  v_lshrrev_b32 v4, 4, v1
  v_and_b32 v5, 15, v1
  v_lshlrev_b32 v6, 2, v4
  v_xor_b32 v6, v6, v5
  v_lshlrev_b32 v6, 4, v6
  v_lshl_add_u32 v6, v4, 8, v6
  s_lshl_b32 s64, s60, 13
  s_add_u32 m0, s64, 0
  s_nop 0
  buffer_load_dwordx4 v6, s[40:43], m0 offen lds
  s_add_u32 m0, s64, 1024
  s_nop 0
  buffer_load_dwordx4 v6, s[40:43], m0 offen lds
  s_add_u32 m0, s64, 2048
  s_nop 0
  buffer_load_dwordx4 v6, s[40:43], m0 offen lds
  s_add_u32 m0, s64, 3072
  s_nop 0
  buffer_load_dwordx4 v6, s[40:43], m0 offen lds
  s_add_u32 m0, s64, 4096
  s_nop 0
  buffer_load_dwordx4 v6, s[40:43], m0 offen lds
  s_add_u32 m0, s64, 5120
  s_nop 0
  buffer_load_dwordx4 v6, s[40:43], m0 offen lds
  s_add_u32 m0, s64, 6144
  s_nop 0
  buffer_load_dwordx4 v6, s[40:43], m0 offen lds
  s_add_u32 m0, s64, 7168
  s_nop 0
  buffer_load_dwordx4 v6, s[40:43], m0 offen lds
  s_mul_i32 s65, s61, 50
  s_lshl_b32 s66, s60, 3
  v_add_u32 v7, s66, v4
  v_add_u32 v100, 0, v7
  v_and_b32 v101, 15, v100
  v_xor_b32 v101, v101, v5
  v_add_u32 v100, s65, v100
  v_lshlrev_b32 v100, 8, v100
  v_lshl_add_u32 v100, v101, 4, v100
  s_lshl_b32 s67, s60, 11
  s_add_u32 m0, s67, 65536
  s_nop 0
  buffer_load_dwordx4 v100, s[20:23], 0 offen lds
  v_add_u32 v100, 4, v7
  v_and_b32 v101, 15, v100
  v_xor_b32 v101, v101, v5
  v_add_u32 v100, s65, v100
  v_lshlrev_b32 v100, 8, v100
  v_lshl_add_u32 v100, v101, 4, v100
  s_lshl_b32 s67, s60, 11
  s_add_u32 m0, s67, 66560
  s_nop 0
  buffer_load_dwordx4 v100, s[20:23], 0 offen lds
  v_and_b32 v100, 15, v2
  v_lshlrev_b32 v101, 8, v2
  v_add_u32 v101, 0x10000, v101
  v_add_u32 v102, 0, v3
  v_xor_b32 v102, v102, v100
  v_lshl_add_u32 v104, v102, 4, v101
  v_add_u32 v102, 2, v3
  v_xor_b32 v102, v102, v100
  v_lshl_add_u32 v105, v102, 4, v101
  v_add_u32 v102, 4, v3
  v_xor_b32 v102, v102, v100
  v_lshl_add_u32 v106, v102, 4, v101
  v_add_u32 v102, 6, v3
  v_xor_b32 v102, v102, v100
  v_lshl_add_u32 v107, v102, 4, v101
  v_add_u32 v102, 8, v3
  v_xor_b32 v102, v102, v100
  v_lshl_add_u32 v108, v102, 4, v101
  v_add_u32 v102, 10, v3
  v_xor_b32 v102, v102, v100
  v_lshl_add_u32 v109, v102, 4, v101
  v_add_u32 v102, 12, v3
  v_xor_b32 v102, v102, v100
  v_lshl_add_u32 v110, v102, 4, v101
  v_add_u32 v102, 14, v3
  v_xor_b32 v102, v102, v100
  v_lshl_add_u32 v111, v102, 4, v101
  v_bfe_u32 v100, v1, 2, 2
  v_and_b32 v101, 3, v1
  v_bfe_u32 v102, v1, 4, 1
  v_lshrrev_b32 v103, 1, v101
  v_lshl_add_u32 v103, v102, 1, v103
  s_lshl_b32 s64, s63, 2
  v_add_u32 v103, s64, v103
  v_lshlrev_b32 v102, 2, v100
  v_xor_b32 v103, v103, v102
  v_lshlrev_b32 v103, 4, v103
  v_and_b32 v101, 1, v101
  v_lshl_add_u32 v103, v101, 3, v103
  v_lshl_add_u32 v100, v3, 3, v100
  s_lshl_b32 s64, s62, 7
  v_add_u32 v100, s64, v100
  v_lshl_add_u32 v112, v100, 8, v103
  s_mov_b32 s70, 0xbfb8aa3b
  s_waitcnt vmcnt(0)
  s_barrier
  ds_read_b64_tr_b16 v[8:9], v112 offset:0
  ds_read_b64_tr_b16 v[10:11], v112 offset:1024
  ds_read_b64_tr_b16 v[12:13], v112 offset:4096
  ds_read_b64_tr_b16 v[14:15], v112 offset:5120
  ds_read_b64_tr_b16 v[16:17], v112 offset:8192
  ds_read_b64_tr_b16 v[18:19], v112 offset:9216
  ds_read_b64_tr_b16 v[20:21], v112 offset:12288
  ds_read_b64_tr_b16 v[22:23], v112 offset:13312
  s_waitcnt lgkmcnt(4)
  ds_read_b64_tr_b16 v[24:25], v112 offset:16384
  ds_read_b64_tr_b16 v[26:27], v112 offset:17408
  ds_read_b64_tr_b16 v[28:29], v112 offset:20480
  ds_read_b64_tr_b16 v[30:31], v112 offset:21504
  ds_read_b64_tr_b16 v[32:33], v112 offset:24576
  ds_read_b64_tr_b16 v[34:35], v112 offset:25600
  ds_read_b64_tr_b16 v[36:37], v112 offset:28672
  ds_read_b64_tr_b16 v[38:39], v112 offset:29696
  ds_read_b128 v[40:43], v104 offset:0
  ds_read_b128 v[44:47], v105 offset:0
  ds_read_b128 v[48:51], v106 offset:0
  ds_read_b128 v[52:55], v107 offset:0
  ds_read_b128 v[56:59], v108 offset:0
  ds_read_b128 v[60:63], v109 offset:0
  ds_read_b128 v[64:67], v110 offset:0
  ds_read_b128 v[68:71], v111 offset:0
  s_waitcnt lgkmcnt(0)
  s_cmp_lg_u32 s62, 0
  s_cbranch_scc1 K1_gB_11
  v_mfma_f32_32x32x16_bf16 v[72:87], v[40:43], v[8:11], 0
  v_mfma_f32_32x32x16_bf16 v[72:87], v[44:47], v[12:15], v[72:87]
  v_mfma_f32_32x32x16_bf16 v[72:87], v[48:51], v[16:19], v[72:87]
  v_mfma_f32_32x32x16_bf16 v[72:87], v[52:55], v[20:23], v[72:87]
  v_mfma_f32_32x32x16_bf16 v[72:87], v[56:59], v[24:27], v[72:87]
  v_mfma_f32_32x32x16_bf16 v[72:87], v[60:63], v[28:31], v[72:87]
  v_mfma_f32_32x32x16_bf16 v[72:87], v[64:67], v[32:35], v[72:87]
  v_mfma_f32_32x32x16_bf16 v[72:87], v[68:71], v[36:39], v[72:87]
  s_branch K1_gJ_12
K1_gB_11:
  s_nop 10
  v_mfma_f32_32x32x16_bf16 v[72:87], v[8:11], v[40:43], 0
  v_mfma_f32_32x32x16_bf16 v[72:87], v[12:15], v[44:47], v[72:87]
  v_mfma_f32_32x32x16_bf16 v[72:87], v[16:19], v[48:51], v[72:87]
  v_mfma_f32_32x32x16_bf16 v[72:87], v[20:23], v[52:55], v[72:87]
  v_mfma_f32_32x32x16_bf16 v[72:87], v[24:27], v[56:59], v[72:87]
  v_mfma_f32_32x32x16_bf16 v[72:87], v[28:31], v[60:63], v[72:87]
  v_mfma_f32_32x32x16_bf16 v[72:87], v[32:35], v[64:67], v[72:87]
  v_mfma_f32_32x32x16_bf16 v[72:87], v[36:39], v[68:71], v[72:87]
K1_gJ_12:
  ds_read_b128 v[40:43], v104 offset:8192
  ds_read_b128 v[44:47], v105 offset:8192
  ds_read_b128 v[48:51], v106 offset:8192
  ds_read_b128 v[52:55], v107 offset:8192
  ds_read_b128 v[56:59], v108 offset:8192
  ds_read_b128 v[60:63], v109 offset:8192
  ds_read_b128 v[64:67], v110 offset:8192
  ds_read_b128 v[68:71], v111 offset:8192
  s_waitcnt lgkmcnt(0)
  s_cmp_lg_u32 s62, 0
  s_cbranch_scc1 K1_gB_13
  v_mfma_f32_32x32x16_bf16 v[88:103], v[40:43], v[8:11], 0
  v_mfma_f32_32x32x16_bf16 v[88:103], v[44:47], v[12:15], v[88:103]
  v_mfma_f32_32x32x16_bf16 v[88:103], v[48:51], v[16:19], v[88:103]
  v_mfma_f32_32x32x16_bf16 v[88:103], v[52:55], v[20:23], v[88:103]
  v_mfma_f32_32x32x16_bf16 v[88:103], v[56:59], v[24:27], v[88:103]
  v_mfma_f32_32x32x16_bf16 v[88:103], v[60:63], v[28:31], v[88:103]
  v_mfma_f32_32x32x16_bf16 v[88:103], v[64:67], v[32:35], v[88:103]
  v_mfma_f32_32x32x16_bf16 v[88:103], v[68:71], v[36:39], v[88:103]
  s_branch K1_gJ_14
K1_gB_13:
  s_nop 10
  v_mfma_f32_32x32x16_bf16 v[88:103], v[8:11], v[40:43], 0
  v_mfma_f32_32x32x16_bf16 v[88:103], v[12:15], v[44:47], v[88:103]
  v_mfma_f32_32x32x16_bf16 v[88:103], v[16:19], v[48:51], v[88:103]
  v_mfma_f32_32x32x16_bf16 v[88:103], v[20:23], v[52:55], v[88:103]
  v_mfma_f32_32x32x16_bf16 v[88:103], v[24:27], v[56:59], v[88:103]
  v_mfma_f32_32x32x16_bf16 v[88:103], v[28:31], v[60:63], v[88:103]
  v_mfma_f32_32x32x16_bf16 v[88:103], v[32:35], v[64:67], v[88:103]
  v_mfma_f32_32x32x16_bf16 v[88:103], v[36:39], v[68:71], v[88:103]
K1_gJ_14:
  s_cmp_lg_u32 s62, 0
  s_cbranch_scc1 K1_GEMM_B
  v_lshlrev_b32 v4, 4, v2
  v_lshlrev_b32 v5, 3, v3
  v_add_u32 v4, v4, v5
  s_lshl_b32 s64, s63, 9
  v_add_u32 v4, s64, v4
  v_mul_f32 v72, s70, v72
  v_mul_f32 v73, s70, v73
  v_mul_f32 v74, s70, v74
  v_mul_f32 v75, s70, v75
  v_cvt_pk_bf16_f32 v72, v72, v73
  v_cvt_pk_bf16_f32 v73, v74, v75
  s_mul_i32 s66, s61, 14336
  s_add_u32 s66, s66, 3200000
  buffer_store_dwordx2 v[72:73], v4, s[48:51], s66 offen
  v_mul_f32 v76, s70, v76
  v_mul_f32 v77, s70, v77
  v_mul_f32 v78, s70, v78
  v_mul_f32 v79, s70, v79
  v_cvt_pk_bf16_f32 v76, v76, v77
  v_cvt_pk_bf16_f32 v77, v78, v79
  s_mul_i32 s66, s61, 14336
  s_add_u32 s66, s66, 3202048
  buffer_store_dwordx2 v[76:77], v4, s[48:51], s66 offen
  v_mul_f32 v80, s70, v80
  v_mul_f32 v81, s70, v81
  v_mul_f32 v82, s70, v82
  v_mul_f32 v83, s70, v83
  v_cvt_pk_bf16_f32 v80, v80, v81
  v_cvt_pk_bf16_f32 v81, v82, v83
  s_mul_i32 s66, s61, 14336
  s_add_u32 s66, s66, 3204096
  buffer_store_dwordx2 v[80:81], v4, s[48:51], s66 offen
  v_mul_f32 v84, s70, v84
  v_mul_f32 v85, s70, v85
  v_mul_f32 v86, s70, v86
  v_mul_f32 v87, s70, v87
  v_cvt_pk_bf16_f32 v84, v84, v85
  v_cvt_pk_bf16_f32 v85, v86, v87
  s_mul_i32 s66, s61, 14336
  s_add_u32 s66, s66, 3206144
  buffer_store_dwordx2 v[84:85], v4, s[48:51], s66 offen
  v_mul_f32 v88, s70, v88
  v_mul_f32 v89, s70, v89
  v_mul_f32 v90, s70, v90
  v_mul_f32 v91, s70, v91
  v_cvt_pk_bf16_f32 v88, v88, v89
  v_cvt_pk_bf16_f32 v89, v90, v91
  s_mul_i32 s66, s61, 14336
  s_add_u32 s66, s66, 3208192
  buffer_store_dwordx2 v[88:89], v4, s[48:51], s66 offen
  v_mul_f32 v92, s70, v92
  v_mul_f32 v93, s70, v93
  v_mul_f32 v94, s70, v94
  v_mul_f32 v95, s70, v95
  v_cvt_pk_bf16_f32 v92, v92, v93
  v_cvt_pk_bf16_f32 v93, v94, v95
  s_mul_i32 s66, s61, 14336
  s_add_u32 s66, s66, 3210240
  buffer_store_dwordx2 v[92:93], v4, s[48:51], s66 offen
  v_mul_f32 v96, s70, v96
  v_mul_f32 v97, s70, v97
  v_mul_f32 v98, s70, v98
  v_mul_f32 v99, s70, v99
  v_cvt_pk_bf16_f32 v96, v96, v97
  v_cvt_pk_bf16_f32 v97, v98, v99
  s_mul_i32 s66, s61, 14336
  s_add_u32 s66, s66, 3212288
  buffer_store_dwordx2 v[96:97], v4, s[48:51], s66 offen
  s_branch K1_END
K1_GEMM_B:
  v_cmp_gt_u32 s[72:73], 18, v2
  v_lshlrev_b32 v5, 3, v3
  v_add_u32 v113, s65, v2
  v_lshlrev_b32 v113, 8, v113
  v_add_u32 v113, v113, v5
  s_lshl_b32 s64, s63, 6
  s_add_u32 s64, s64, 0
  v_mul_f32 v72, s70, v72
  v_mul_f32 v73, s70, v73
  v_mul_f32 v74, s70, v74
  v_mul_f32 v75, s70, v75
  v_cvt_pk_bf16_f32 v72, v72, v73
  v_cvt_pk_bf16_f32 v73, v74, v75
  buffer_store_dwordx2 v[72:73], v113, s[48:51], s64 offen offset:0
  v_mul_f32 v76, s70, v76
  v_mul_f32 v77, s70, v77
  v_mul_f32 v78, s70, v78
  v_mul_f32 v79, s70, v79
  v_cvt_pk_bf16_f32 v76, v76, v77
  v_cvt_pk_bf16_f32 v77, v78, v79
  buffer_store_dwordx2 v[76:77], v113, s[48:51], s64 offen offset:16
  v_mul_f32 v80, s70, v80
  v_mul_f32 v81, s70, v81
  v_mul_f32 v82, s70, v82
  v_mul_f32 v83, s70, v83
  v_cvt_pk_bf16_f32 v80, v80, v81
  v_cvt_pk_bf16_f32 v81, v82, v83
  buffer_store_dwordx2 v[80:81], v113, s[48:51], s64 offen offset:32
  v_mul_f32 v84, s70, v84
  v_mul_f32 v85, s70, v85
  v_mul_f32 v86, s70, v86
  v_mul_f32 v87, s70, v87
  v_cvt_pk_bf16_f32 v84, v84, v85
  v_cvt_pk_bf16_f32 v85, v86, v87
  buffer_store_dwordx2 v[84:85], v113, s[48:51], s64 offen offset:48
  v_add_u32 v113, 8192, v113
  s_mov_b64 exec, s[72:73]
  v_mul_f32 v88, s70, v88
  v_mul_f32 v89, s70, v89
  v_mul_f32 v90, s70, v90
  v_mul_f32 v91, s70, v91
  v_cvt_pk_bf16_f32 v88, v88, v89
  v_cvt_pk_bf16_f32 v89, v90, v91
  buffer_store_dwordx2 v[88:89], v113, s[48:51], s64 offen offset:0
  v_mul_f32 v92, s70, v92
  v_mul_f32 v93, s70, v93
  v_mul_f32 v94, s70, v94
  v_mul_f32 v95, s70, v95
  v_cvt_pk_bf16_f32 v92, v92, v93
  v_cvt_pk_bf16_f32 v93, v94, v95
  buffer_store_dwordx2 v[92:93], v113, s[48:51], s64 offen offset:16
  v_mul_f32 v96, s70, v96
  v_mul_f32 v97, s70, v97
  v_mul_f32 v98, s70, v98
  v_mul_f32 v99, s70, v99
  v_cvt_pk_bf16_f32 v96, v96, v97
  v_cvt_pk_bf16_f32 v97, v98, v99
  buffer_store_dwordx2 v[96:97], v113, s[48:51], s64 offen offset:32
  v_mul_f32 v100, s70, v100
  v_mul_f32 v101, s70, v101
  v_mul_f32 v102, s70, v102
  v_mul_f32 v103, s70, v103
  v_cvt_pk_bf16_f32 v100, v100, v101
  v_cvt_pk_bf16_f32 v101, v102, v103
  buffer_store_dwordx2 v[100:101], v113, s[48:51], s64 offen offset:48
  s_mov_b64 exec, -1
  s_branch K1_END
K1_WPREP:
  v_and_b32 v2, 31, v1
  v_lshrrev_b32 v3, 5, v1
  v_lshlrev_b32 v4, 11, v3
  v_lshlrev_b32 v5, 1, v2
  v_add_u32 v4, v4, v5
  v_lshlrev_b32 v6, 4, v1
  s_lshr_b32 s61, s60, 1
  s_and_b32 s62, s60, 1
  s_lshl_b32 s62, s62, 3
  s_lshl_b32 s63, s61, 6
  v_add_u32 v4, s63, v4
  s_lshl_b32 s64, s62, 12
  s_lshl_b32 s65, s60, 13
  s_add_u32 s65, s65, 15040000
  buffer_load_ushort v64, v4, s[44:47], s64 offen offset:0
  buffer_load_ushort v65, v4, s[44:47], s64 offen offset:256
  buffer_load_ushort v66, v4, s[44:47], s64 offen offset:512
  buffer_load_ushort v67, v4, s[44:47], s64 offen offset:768
  buffer_load_ushort v68, v4, s[44:47], s64 offen offset:1024
  buffer_load_ushort v69, v4, s[44:47], s64 offen offset:1280
  buffer_load_ushort v70, v4, s[44:47], s64 offen offset:1536
  buffer_load_ushort v71, v4, s[44:47], s64 offen offset:1792
  s_add_u32 s64, s64, 4096
  buffer_load_ushort v72, v4, s[44:47], s64 offen offset:0
  buffer_load_ushort v73, v4, s[44:47], s64 offen offset:256
  buffer_load_ushort v74, v4, s[44:47], s64 offen offset:512
  buffer_load_ushort v75, v4, s[44:47], s64 offen offset:768
  buffer_load_ushort v76, v4, s[44:47], s64 offen offset:1024
  buffer_load_ushort v77, v4, s[44:47], s64 offen offset:1280
  buffer_load_ushort v78, v4, s[44:47], s64 offen offset:1536
  buffer_load_ushort v79, v4, s[44:47], s64 offen offset:1792
  s_add_u32 s64, s64, 4096
  buffer_load_ushort v80, v4, s[44:47], s64 offen offset:0
  buffer_load_ushort v81, v4, s[44:47], s64 offen offset:256
  buffer_load_ushort v82, v4, s[44:47], s64 offen offset:512
  buffer_load_ushort v83, v4, s[44:47], s64 offen offset:768
  buffer_load_ushort v84, v4, s[44:47], s64 offen offset:1024
  buffer_load_ushort v85, v4, s[44:47], s64 offen offset:1280
  buffer_load_ushort v86, v4, s[44:47], s64 offen offset:1536
  buffer_load_ushort v87, v4, s[44:47], s64 offen offset:1792
  s_add_u32 s64, s64, 4096
  buffer_load_ushort v88, v4, s[44:47], s64 offen offset:0
  buffer_load_ushort v89, v4, s[44:47], s64 offen offset:256
  buffer_load_ushort v90, v4, s[44:47], s64 offen offset:512
  buffer_load_ushort v91, v4, s[44:47], s64 offen offset:768
  buffer_load_ushort v92, v4, s[44:47], s64 offen offset:1024
  buffer_load_ushort v93, v4, s[44:47], s64 offen offset:1280
  buffer_load_ushort v94, v4, s[44:47], s64 offen offset:1536
  buffer_load_ushort v95, v4, s[44:47], s64 offen offset:1792
  s_add_u32 s64, s64, 4096
  buffer_load_ushort v96, v4, s[44:47], s64 offen offset:0
  buffer_load_ushort v97, v4, s[44:47], s64 offen offset:256
  buffer_load_ushort v98, v4, s[44:47], s64 offen offset:512
  buffer_load_ushort v99, v4, s[44:47], s64 offen offset:768
  buffer_load_ushort v100, v4, s[44:47], s64 offen offset:1024
  buffer_load_ushort v101, v4, s[44:47], s64 offen offset:1280
  buffer_load_ushort v102, v4, s[44:47], s64 offen offset:1536
  buffer_load_ushort v103, v4, s[44:47], s64 offen offset:1792
  s_add_u32 s64, s64, 4096
  buffer_load_ushort v104, v4, s[44:47], s64 offen offset:0
  buffer_load_ushort v105, v4, s[44:47], s64 offen offset:256
  buffer_load_ushort v106, v4, s[44:47], s64 offen offset:512
  buffer_load_ushort v107, v4, s[44:47], s64 offen offset:768
  buffer_load_ushort v108, v4, s[44:47], s64 offen offset:1024
  buffer_load_ushort v109, v4, s[44:47], s64 offen offset:1280
  buffer_load_ushort v110, v4, s[44:47], s64 offen offset:1536
  buffer_load_ushort v111, v4, s[44:47], s64 offen offset:1792
  s_add_u32 s64, s64, 4096
  buffer_load_ushort v112, v4, s[44:47], s64 offen offset:0
  buffer_load_ushort v113, v4, s[44:47], s64 offen offset:256
  buffer_load_ushort v114, v4, s[44:47], s64 offen offset:512
  buffer_load_ushort v115, v4, s[44:47], s64 offen offset:768
  buffer_load_ushort v116, v4, s[44:47], s64 offen offset:1024
  buffer_load_ushort v117, v4, s[44:47], s64 offen offset:1280
  buffer_load_ushort v118, v4, s[44:47], s64 offen offset:1536
  buffer_load_ushort v119, v4, s[44:47], s64 offen offset:1792
  s_add_u32 s64, s64, 4096
  buffer_load_ushort v120, v4, s[44:47], s64 offen offset:0
  buffer_load_ushort v121, v4, s[44:47], s64 offen offset:256
  buffer_load_ushort v122, v4, s[44:47], s64 offen offset:512
  buffer_load_ushort v123, v4, s[44:47], s64 offen offset:768
  buffer_load_ushort v124, v4, s[44:47], s64 offen offset:1024
  buffer_load_ushort v125, v4, s[44:47], s64 offen offset:1280
  buffer_load_ushort v126, v4, s[44:47], s64 offen offset:1536
  buffer_load_ushort v127, v4, s[44:47], s64 offen offset:1792
  s_add_u32 s64, s64, 4096
  s_cmp_gt_u32 s60, 1
  s_cbranch_scc1 K1_W_NOF5
  s_lshl_b32 s66, s60, 7
  v_lshlrev_b32 v40, 1, v1
  v_add_u32 v40, s66, v40
  s_mov_b32 s67, 65536
  buffer_load_ushort v41, v40, s[40:43], s67 offen offset:0
  buffer_load_ushort v42, v40, s[40:43], s67 offen offset:256
  buffer_load_ushort v43, v40, s[40:43], s67 offen offset:512
  buffer_load_ushort v44, v40, s[40:43], s67 offen offset:768
  buffer_load_ushort v45, v40, s[40:43], s67 offen offset:1024
  s_mov_b32 s70, 0xbfb8aa3b
  s_waitcnt vmcnt(0)
  v_lshlrev_b32 v41, 16, v41
  v_lshlrev_b32 v42, 16, v42
  v_lshlrev_b32 v43, 16, v43
  v_lshlrev_b32 v44, 16, v44
  v_lshlrev_b32 v45, 16, v45
  v_mov_b32 v46, 0
  v_cvt_pk_bf16_f32 v48, v42, v43
  v_cvt_pk_bf16_f32 v49, v44, v45
  v_cvt_pk_bf16_f32 v50, v41, v46
  v_mov_b32 v51, 0
  s_lshl_b32 s66, s60, 10
  s_add_u32 s66, s66, 15105536
  buffer_store_dwordx4 v[48:51], v6, s[48:51], s66 offen
K1_W_NOF5:
  s_waitcnt vmcnt(0)
  v_lshl_or_b32 v8, v65, 16, v64
  v_lshl_or_b32 v9, v67, 16, v66
  v_lshl_or_b32 v10, v69, 16, v68
  v_lshl_or_b32 v11, v71, 16, v70
  v_lshl_or_b32 v12, v73, 16, v72
  v_lshl_or_b32 v13, v75, 16, v74
  v_lshl_or_b32 v14, v77, 16, v76
  v_lshl_or_b32 v15, v79, 16, v78
  v_lshl_or_b32 v16, v81, 16, v80
  v_lshl_or_b32 v17, v83, 16, v82
  v_lshl_or_b32 v18, v85, 16, v84
  v_lshl_or_b32 v19, v87, 16, v86
  v_lshl_or_b32 v20, v89, 16, v88
  v_lshl_or_b32 v21, v91, 16, v90
  v_lshl_or_b32 v22, v93, 16, v92
  v_lshl_or_b32 v23, v95, 16, v94
  v_lshl_or_b32 v24, v97, 16, v96
  v_lshl_or_b32 v25, v99, 16, v98
  v_lshl_or_b32 v26, v101, 16, v100
  v_lshl_or_b32 v27, v103, 16, v102
  v_lshl_or_b32 v28, v105, 16, v104
  v_lshl_or_b32 v29, v107, 16, v106
  v_lshl_or_b32 v30, v109, 16, v108
  v_lshl_or_b32 v31, v111, 16, v110
  v_lshl_or_b32 v32, v113, 16, v112
  v_lshl_or_b32 v33, v115, 16, v114
  v_lshl_or_b32 v34, v117, 16, v116
  v_lshl_or_b32 v35, v119, 16, v118
  v_lshl_or_b32 v36, v121, 16, v120
  v_lshl_or_b32 v37, v123, 16, v122
  v_lshl_or_b32 v38, v125, 16, v124
  v_lshl_or_b32 v39, v127, 16, v126
  buffer_store_dwordx4 v[8:11], v6, s[48:51], s65 offen offset:0
  buffer_store_dwordx4 v[12:15], v6, s[48:51], s65 offen offset:1024
  buffer_store_dwordx4 v[16:19], v6, s[48:51], s65 offen offset:2048
  buffer_store_dwordx4 v[20:23], v6, s[48:51], s65 offen offset:3072
  v_add_u32 v7, 4096, v6
  buffer_store_dwordx4 v[24:27], v7, s[48:51], s65 offen offset:0
  buffer_store_dwordx4 v[28:31], v7, s[48:51], s65 offen offset:1024
  buffer_store_dwordx4 v[32:35], v7, s[48:51], s65 offen offset:2048
  buffer_store_dwordx4 v[36:39], v7, s[48:51], s65 offen offset:3072
K1_END:
K1_EXIT:
  s_endpgm
.globl standalone__cheap_equivariant_egnn__graph_kernel
.p2align 8
.type standalone__cheap_equivariant_egnn__graph_kernel,@function
standalone__cheap_equivariant_egnn__graph_kernel:
  s_cmp_ge_u32 s2, 250
  s_cbranch_scc1 K2_EXIT
  s_load_dwordx2 s[4:5], s[0:1], 0
  s_load_dwordx2 s[6:7], s[0:1], 8
  s_load_dwordx2 s[8:9], s[0:1], 48
  s_load_dwordx2 s[10:11], s[0:1], 64
  s_load_dwordx2 s[12:13], s[0:1], 80
  v_and_b32 v1, 63, v0
  v_and_b32 v2, 31, v1
  v_lshrrev_b32 v3, 5, v1
  v_lshrrev_b32 v192, 6, v0
  s_nop 0
  v_readfirstlane_b32 s36, v192
  s_mul_i32 s37, s2, 50
  s_waitcnt lgkmcnt(0)
  s_mov_b32 s20, s4
  s_mov_b32 s21, s5
  s_mov_b32 s22, 3200000
  s_mov_b32 s23, 0x00020000
  s_mov_b32 s28, s6
  s_mov_b32 s29, s7
  s_mov_b32 s30, 75000
  s_mov_b32 s31, 0x00020000
  s_mov_b32 s32, s8
  s_mov_b32 s33, s9
  s_mov_b32 s34, 256
  s_mov_b32 s35, 0x00020000
  s_mov_b32 s24, s10
  s_mov_b32 s25, s11
  s_mov_b32 s26, 3275000
  s_mov_b32 s27, 0x00020000
  s_mov_b32 s16, s12
  s_mov_b32 s17, s13
  s_mov_b32 s18, 268435456
  s_mov_b32 s19, 0x00020000
  s_lshl_b32 s59, s2, 10
  s_add_u32 s59, s59, 14784000
  v_lshlrev_b32 v194, 2, v1
  v_lshlrev_b32 v195, 4, v1
  buffer_load_dword v241, v194, s[16:19], s59 offen
  buffer_load_dword v242, v194, s[16:19], s59 offen offset:256
  buffer_load_dword v243, v194, s[16:19], s59 offen offset:512
  buffer_load_dword v244, v194, s[16:19], s59 offen offset:768
  s_mul_i32 s61, s2, 14336
  s_add_u32 s61, s61, 3200000
  s_lshl_b32 s62, s36, 10
  s_add_u32 s63, s61, s62
  s_add_u32 m0, s62, 148640
  s_nop 0
  buffer_load_dwordx4 v195, s[16:19], s63 offen lds
  s_cmp_ge_u32 s36, 6
  s_cbranch_scc1 K2_noat2
  s_add_u32 s63, s63, 8192
  s_add_u32 m0, s62, 156832
  s_nop 0
  buffer_load_dwordx4 v195, s[16:19], s63 offen lds
K2_noat2:
  v_lshlrev_b32 v193, 4, v2
  s_mov_b32 s59, 15105536
  buffer_load_dwordx4 v[28:31], v193, s[16:19], s59 offen offset:0
  buffer_load_dwordx4 v[32:35], v193, s[16:19], s59 offen offset:512
  buffer_load_dwordx4 v[36:39], v193, s[16:19], s59 offen offset:1024
  buffer_load_dwordx4 v[40:43], v193, s[16:19], s59 offen offset:1536
  v_lshlrev_b32 v193, 1, v2
  buffer_load_ushort v44, v193, s[32:35], 0 offen offset:0
  buffer_load_ushort v45, v193, s[32:35], 0 offen offset:64
  buffer_load_ushort v46, v193, s[32:35], 0 offen offset:128
  buffer_load_ushort v47, v193, s[32:35], 0 offen offset:192
  s_lshl_b32 s55, s36, 13
  s_mov_b32 s56, 0
  s_mov_b32 s57, -1
  s_mov_b32 s58, 0xffffff00
  s_mov_b32 s14, 0x80000000
  s_mov_b32 s15, 0x80000000
  v_mov_b32 v60, 0
  v_mov_b32 v61, 0
  v_mov_b32 v62, 0
  v_mov_b32 v63, 0
  v_and_b32 v192, 7, v2
  v_lshlrev_b32 v192, 2, v192
  v_lshrrev_b32 v193, 3, v2
  v_add_u32 v192, v192, v193
  v_lshlrev_b32 v192, 8, v192
  v_add_u32 v192, s55, v192
  v_and_b32 v193, 15, v2
  v_add_u32 v194, 0, v3
  v_xor_b32 v194, v194, v193
  v_lshl_add_u32 v4, v194, 4, v192
  v_add_u32 v194, 2, v3
  v_xor_b32 v194, v194, v193
  v_lshl_add_u32 v5, v194, 4, v192
  v_add_u32 v194, 4, v3
  v_xor_b32 v194, v194, v193
  v_lshl_add_u32 v6, v194, 4, v192
  v_add_u32 v194, 6, v3
  v_xor_b32 v194, v194, v193
  v_lshl_add_u32 v7, v194, 4, v192
  v_add_u32 v194, 8, v3
  v_xor_b32 v194, v194, v193
  v_lshl_add_u32 v8, v194, 4, v192
  v_add_u32 v194, 10, v3
  v_xor_b32 v194, v194, v193
  v_lshl_add_u32 v9, v194, 4, v192
  v_add_u32 v194, 12, v3
  v_xor_b32 v194, v194, v193
  v_lshl_add_u32 v10, v194, 4, v192
  v_add_u32 v194, 14, v3
  v_xor_b32 v194, v194, v193
  v_lshl_add_u32 v11, v194, 4, v192
  v_and_b32 v193, 15, v1
  v_bfe_u32 v194, v1, 4, 1
  v_lshlrev_b32 v194, 3, v194
  v_xor_b32 v193, v193, v194
  v_xor_b32 v194, 0, v193
  v_lshlrev_b32 v12, 4, v194
  v_xor_b32 v194, 1, v193
  v_lshlrev_b32 v13, 4, v194
  v_xor_b32 v194, 2, v193
  v_lshlrev_b32 v14, 4, v194
  v_xor_b32 v194, 3, v193
  v_lshlrev_b32 v15, 4, v194
  v_xor_b32 v194, 4, v193
  v_lshlrev_b32 v16, 4, v194
  v_xor_b32 v194, 5, v193
  v_lshlrev_b32 v17, 4, v194
  v_xor_b32 v194, 6, v193
  v_lshlrev_b32 v18, 4, v194
  v_xor_b32 v194, 7, v193
  v_lshlrev_b32 v19, 4, v194
  v_mov_b32 v196, 0x3f80
  v_mov_b32 v197, 0x3f800000
  v_lshlrev_b32 v192, 3, v3
  v_sub_u32 v192, v2, v192
  v_cmp_eq_u32 vcc, 0, v192
  s_nop 1
  v_cndmask_b32 v20, 0, v196, vcc
  v_cmp_eq_u32 vcc, 1, v192
  s_nop 1
  v_cndmask_b32 v20, v20, v197, vcc
  v_cmp_eq_u32 vcc, 2, v192
  s_nop 1
  v_cndmask_b32 v21, 0, v196, vcc
  v_cmp_eq_u32 vcc, 3, v192
  s_nop 1
  v_cndmask_b32 v21, v21, v197, vcc
  v_cmp_eq_u32 vcc, 4, v192
  s_nop 1
  v_cndmask_b32 v22, 0, v196, vcc
  v_cmp_eq_u32 vcc, 5, v192
  s_nop 1
  v_cndmask_b32 v22, v22, v197, vcc
  v_cmp_eq_u32 vcc, 6, v192
  s_nop 1
  v_cndmask_b32 v23, 0, v196, vcc
  v_cmp_eq_u32 vcc, 7, v192
  s_nop 1
  v_cndmask_b32 v23, v23, v197, vcc
  v_subrev_u32 v192, 16, v192
  v_cmp_eq_u32 vcc, 0, v192
  s_nop 1
  v_cndmask_b32 v24, 0, v196, vcc
  v_cmp_eq_u32 vcc, 1, v192
  s_nop 1
  v_cndmask_b32 v24, v24, v197, vcc
  v_cmp_eq_u32 vcc, 2, v192
  s_nop 1
  v_cndmask_b32 v25, 0, v196, vcc
  v_cmp_eq_u32 vcc, 3, v192
  s_nop 1
  v_cndmask_b32 v25, v25, v197, vcc
  v_cmp_eq_u32 vcc, 4, v192
  s_nop 1
  v_cndmask_b32 v26, 0, v196, vcc
  v_cmp_eq_u32 vcc, 5, v192
  s_nop 1
  v_cndmask_b32 v26, v26, v197, vcc
  v_cmp_eq_u32 vcc, 6, v192
  s_nop 1
  v_cndmask_b32 v27, 0, v196, vcc
  v_cmp_eq_u32 vcc, 7, v192
  s_nop 1
  v_cndmask_b32 v27, v27, v197, vcc
  s_lshl_b32 s59, s36, 11
  s_add_u32 s59, s59, 105856
  v_lshlrev_b32 v192, 6, v2
  v_lshl_add_u32 v192, v3, 4, v192
  v_add_u32 v48, s59, v192
  v_lshlrev_b32 v192, 4, v1
  v_add_u32 v50, s59, v192
  v_lshrrev_b32 v192, 4, v2
  v_lshlrev_b32 v192, 5, v192
  v_bfe_u32 v193, v2, 2, 1
  v_lshl_add_u32 v192, v193, 4, v192
  v_bfe_u32 v193, v2, 3, 1
  v_lshl_add_u32 v192, v193, 3, v192
  v_and_b32 v193, 3, v2
  v_lshl_add_u32 v192, v193, 1, v192
  v_lshl_add_u32 v192, v3, 7, v192
  v_add_u32 v49, s59, v192
  v_mov_b32 v192, 0xffff0000
  v_mov_b32 v193, -1
  v_cndmask_b32 v51, v192, v193, s[56:57]
  v_mov_b32 v193, 0
  v_cndmask_b32 v52, v196, v193, s[56:57]
  v_lshrrev_b32 v192, 4, v1
  v_lshlrev_b32 v192, 5, v192
  v_add_u32 v53, 97792, v192
  v_lshlrev_b32 v192, 2, v2
  v_add_u32 v54, 97792, v192
  v_lshlrev_b32 v192, 4, v2
  v_add_u32 v56, 65536, v192
  v_lshlrev_b32 v193, 2, v3
  v_add3_u32 v55, v56, v193, 8
  v_mul_u32_u24 v192, 528, v3
  v_add_u32 v59, 122240, v192
  v_lshlrev_b32 v193, 2, v2
  v_add_u32 v57, v59, v193
  v_lshlrev_b32 v192, 4, v0
  v_add_u32 v192, 122240, v192
  ds_write_b128 v192, v[60:63]
  ds_write_b128 v192, v[60:63] offset:8192
  ds_write_b128 v192, v[60:63] offset:16384
  v_cmp_gt_u32 vcc, 114, v0
  s_nop 1
  s_and_saveexec_b64 s[62:63], vcc
  s_cbranch_execz K2_z1
  ds_write_b128 v192, v[60:63] offset:24576
K2_z1:
  s_mov_b64 exec, s[62:63]
  s_cmp_lg_u32 s36, 0
  s_cbranch_scc1 K2_z2
  v_cmp_eq_u32 vcc, 0, v1
  s_nop 1
  v_cndmask_b32 v204, 0, v196, vcc
  v_cmp_eq_u32 vcc, 1, v1
  s_nop 1
  v_cndmask_b32 v204, v204, v197, vcc
  v_cmp_eq_u32 vcc, 2, v1
  s_nop 1
  v_cndmask_b32 v205, 0, v196, vcc
  v_cmp_eq_u32 vcc, 3, v1
  s_nop 1
  v_cndmask_b32 v205, v205, v197, vcc
  v_cmp_eq_u32 vcc, 4, v1
  s_nop 1
  v_cndmask_b32 v206, 0, v196, vcc
  v_cmp_eq_u32 vcc, 5, v1
  s_nop 1
  v_cndmask_b32 v206, v206, v197, vcc
  v_cmp_eq_u32 vcc, 6, v1
  s_nop 1
  v_cndmask_b32 v207, 0, v196, vcc
  v_cmp_eq_u32 vcc, 7, v1
  s_nop 1
  v_cndmask_b32 v207, v207, v197, vcc
  v_cmp_gt_u32 vcc, 8, v1
  s_nop 1
  s_and_saveexec_b64 s[62:63], vcc
  v_lshlrev_b32 v192, 4, v1
  v_add_u32 v192, 162976, v192
  ds_write_b128 v192, v[204:207]
  s_mov_b64 exec, s[62:63]
K2_z2:
  s_waitcnt vmcnt(9)
  v_lshrrev_b32 v208, 16, v241
  v_lshrrev_b32 v209, 16, v242
  v_lshrrev_b32 v210, 16, v243
  v_lshrrev_b32 v211, 16, v244
  v_cmp_gt_u32 vcc, 58, v1
  s_nop 1
  v_cndmask_b32 v211, 0, v211, vcc
  v_mov_b32 v212, v208
  v_mov_b32 v213, v209
  v_mov_b32 v214, v210
  v_mov_b32 v215, v211
  v_add_u32_dpp v212, v212, v212 row_shr:1 row_mask:0xf bank_mask:0xf bound_ctrl:0
  v_add_u32_dpp v213, v213, v213 row_shr:1 row_mask:0xf bank_mask:0xf bound_ctrl:0
  v_add_u32_dpp v214, v214, v214 row_shr:1 row_mask:0xf bank_mask:0xf bound_ctrl:0
  v_add_u32_dpp v215, v215, v215 row_shr:1 row_mask:0xf bank_mask:0xf bound_ctrl:0
  v_add_u32_dpp v212, v212, v212 row_shr:2 row_mask:0xf bank_mask:0xf bound_ctrl:0
  v_add_u32_dpp v213, v213, v213 row_shr:2 row_mask:0xf bank_mask:0xf bound_ctrl:0
  v_add_u32_dpp v214, v214, v214 row_shr:2 row_mask:0xf bank_mask:0xf bound_ctrl:0
  v_add_u32_dpp v215, v215, v215 row_shr:2 row_mask:0xf bank_mask:0xf bound_ctrl:0
  v_add_u32_dpp v212, v212, v212 row_shr:4 row_mask:0xf bank_mask:0xf bound_ctrl:0
  v_add_u32_dpp v213, v213, v213 row_shr:4 row_mask:0xf bank_mask:0xf bound_ctrl:0
  v_add_u32_dpp v214, v214, v214 row_shr:4 row_mask:0xf bank_mask:0xf bound_ctrl:0
  v_add_u32_dpp v215, v215, v215 row_shr:4 row_mask:0xf bank_mask:0xf bound_ctrl:0
  v_add_u32_dpp v212, v212, v212 row_shr:8 row_mask:0xf bank_mask:0xf bound_ctrl:0
  v_add_u32_dpp v213, v213, v213 row_shr:8 row_mask:0xf bank_mask:0xf bound_ctrl:0
  v_add_u32_dpp v214, v214, v214 row_shr:8 row_mask:0xf bank_mask:0xf bound_ctrl:0
  v_add_u32_dpp v215, v215, v215 row_shr:8 row_mask:0xf bank_mask:0xf bound_ctrl:0
  v_add_u32_dpp v212, v212, v212 row_bcast:15 row_mask:0xa bank_mask:0xf
  v_add_u32_dpp v213, v213, v213 row_bcast:15 row_mask:0xa bank_mask:0xf
  v_add_u32_dpp v214, v214, v214 row_bcast:15 row_mask:0xa bank_mask:0xf
  v_add_u32_dpp v215, v215, v215 row_bcast:15 row_mask:0xa bank_mask:0xf
  v_add_u32_dpp v212, v212, v212 row_bcast:31 row_mask:0xc bank_mask:0xf
  v_add_u32_dpp v213, v213, v213 row_bcast:31 row_mask:0xc bank_mask:0xf
  v_add_u32_dpp v214, v214, v214 row_bcast:31 row_mask:0xc bank_mask:0xf
  v_add_u32_dpp v215, v215, v215 row_bcast:31 row_mask:0xc bank_mask:0xf
  v_readlane_b32 s59, v212, 63
  v_readlane_b32 s60, v213, 63
  v_readlane_b32 s61, v214, 63
  v_readlane_b32 s62, v215, 63
  s_add_u32 s60, s60, s59
  s_add_u32 s61, s61, s60
  s_add_u32 s5, s62, s61
  v_mov_b32 v217, 0
  v_mov_b32 v216, 0
  v_mov_b32 v253, 0
  s_cmp_lg_u32 s36, 0
  s_cbranch_scc1 K2_sel_1
  v_mov_b32 v217, v208
  v_sub_u32 v216, v212, v208
  v_add_u32 v216, 0, v216
  v_add_u32 v192, 0, v1
  v_mul_u32_u24 v192, 1600, v192
  v_and_b32 v253, 0xffff, v241
  v_add_u32 v253, v253, v192
K2_sel_1:
  s_cmp_lg_u32 s36, 1
  s_cbranch_scc1 K2_sel_2
  v_mov_b32 v217, v209
  v_sub_u32 v216, v213, v209
  v_add_u32 v216, s59, v216
  v_add_u32 v192, 64, v1
  v_mul_u32_u24 v192, 1600, v192
  v_and_b32 v253, 0xffff, v242
  v_add_u32 v253, v253, v192
K2_sel_2:
  s_cmp_lg_u32 s36, 2
  s_cbranch_scc1 K2_sel_3
  v_mov_b32 v217, v210
  v_sub_u32 v216, v214, v210
  v_add_u32 v216, s60, v216
  v_add_u32 v192, 128, v1
  v_mul_u32_u24 v192, 1600, v192
  v_and_b32 v253, 0xffff, v243
  v_add_u32 v253, v253, v192
K2_sel_3:
  s_cmp_lg_u32 s36, 3
  s_cbranch_scc1 K2_sel_4
  v_mov_b32 v217, v211
  v_sub_u32 v216, v215, v211
  v_add_u32 v216, s61, v216
  v_add_u32 v192, 192, v1
  v_mul_u32_u24 v192, 1600, v192
  v_and_b32 v253, 0xffff, v244
  v_add_u32 v253, v253, v192
K2_sel_4:
  v_lshl_or_b32 v252, v216, 11, v217
  v_lshlrev_b32 v192, 4, v253
  s_mov_b32 s59, 6784000
  buffer_load_dword v236, v192, s[16:19], s59 offen
  v_lshlrev_b32 v192, 2, v253
  s_mov_b32 s59, 13184000
  buffer_load_dword v237, v192, s[16:19], s59 offen
  s_mov_b32 s4, 0
K2_ROUND:
  s_mov_b32 s45, 7
  s_sub_u32 s6, s5, s4
  s_min_u32 s6, s6, 1799
  v_and_b32 v192, 7, v1
  v_lshlrev_b32 v192, 2, v192
  v_add_u32 v192, 163104, v192
  ds_write_b32 v192, v60
  v_lshrrev_b32 v216, 11, v252
  v_and_b32 v217, 0x7ff, v252
  v_subrev_u32 v192, v216, v60
  v_add_u32 v192, s4, v192
  v_med3_i32 v193, v192, 0, v217
  v_add_u32 v192, 1799, v192
  v_med3_i32 v194, v192, 0, v217
  v_add_u32 v196, v216, v193
  v_subrev_u32 v196, s4, v196
  v_lshlrev_b32 v196, 2, v196
  v_add_u32 v197, v253, v193
K2_EXP:
  v_cmp_lt_u32 vcc, v193, v194
  s_nop 1
  s_and_b64 exec, exec, vcc
  s_cbranch_execz K2_EXPD
  ds_write_b32 v196, v197 offset:0
  v_add_u32 v193, 1, v193
  v_add_u32 v196, 4, v196
  v_add_u32 v197, 1, v197
  s_nop 0
  s_branch K2_EXP
K2_EXPD:
  s_mov_b64 exec, -1
  s_waitcnt lgkmcnt(0)
  s_barrier
  v_lshlrev_b32 v192, 2, v0
  ds_read_b32 v144, v192 offset:0
  ds_read_b32 v145, v192 offset:2048
  ds_read_b32 v146, v192 offset:4096
  ds_read_b32 v147, v192 offset:6144
  s_mov_b32 s59, 6784000
  s_mov_b32 s60, 13184000
  s_waitcnt lgkmcnt(0)
  s_sub_u32 s61, s6, 0
  s_max_i32 s61, s61, 0
  v_cmp_gt_u32 s[64:65], s61, v0
  v_lshlrev_b32 v196, 4, v144
  v_lshlrev_b32 v197, 2, v144
  s_mov_b64 exec, s[64:65]
  buffer_load_dword v128, v197, s[16:19], s60 offen
  buffer_load_dwordx4 v[64:67], v196, s[16:19], s59 offen
  s_mov_b64 exec, -1
  s_sub_u32 s61, s6, 512
  s_max_i32 s61, s61, 0
  v_cmp_gt_u32 s[66:67], s61, v0
  v_lshlrev_b32 v196, 4, v145
  v_lshlrev_b32 v197, 2, v145
  s_mov_b64 exec, s[66:67]
  buffer_load_dword v129, v197, s[16:19], s60 offen
  buffer_load_dwordx4 v[68:71], v196, s[16:19], s59 offen
  s_mov_b64 exec, -1
  s_sub_u32 s61, s6, 1024
  s_max_i32 s61, s61, 0
  v_cmp_gt_u32 s[68:69], s61, v0
  v_lshlrev_b32 v196, 4, v146
  v_lshlrev_b32 v197, 2, v146
  s_mov_b64 exec, s[68:69]
  buffer_load_dword v130, v197, s[16:19], s60 offen
  buffer_load_dwordx4 v[72:75], v196, s[16:19], s59 offen
  s_mov_b64 exec, -1
  s_sub_u32 s61, s6, 1536
  s_max_i32 s61, s61, 0
  v_cmp_gt_u32 s[70:71], s61, v0
  v_lshlrev_b32 v196, 4, v147
  v_lshlrev_b32 v197, 2, v147
  s_mov_b64 exec, s[70:71]
  buffer_load_dword v131, v197, s[16:19], s60 offen
  buffer_load_dwordx4 v[76:79], v196, s[16:19], s59 offen
  s_mov_b64 exec, -1
  v_mov_b32 v192, 1
  s_mov_b32 s59, 163104
  s_waitcnt vmcnt(7)
  v_bfe_u32 v193, v128, 3, 3
  v_lshl_add_u32 v193, v193, 2, s59
  s_mov_b64 exec, s[64:65]
  ds_add_rtn_u32 v144, v193, v192
  s_mov_b64 exec, -1
  s_waitcnt vmcnt(5)
  v_bfe_u32 v193, v129, 3, 3
  v_lshl_add_u32 v193, v193, 2, s59
  s_mov_b64 exec, s[66:67]
  ds_add_rtn_u32 v145, v193, v192
  s_mov_b64 exec, -1
  s_waitcnt vmcnt(3)
  v_bfe_u32 v193, v130, 3, 3
  v_lshl_add_u32 v193, v193, 2, s59
  s_mov_b64 exec, s[68:69]
  ds_add_rtn_u32 v146, v193, v192
  s_mov_b64 exec, -1
  s_waitcnt vmcnt(1)
  v_bfe_u32 v193, v131, 3, 3
  v_lshl_add_u32 v193, v193, 2, s59
  s_mov_b64 exec, s[70:71]
  ds_add_rtn_u32 v147, v193, v192
  s_mov_b64 exec, -1
  s_waitcnt lgkmcnt(0)
  s_barrier
  v_and_b32 v192, 7, v1
  v_lshlrev_b32 v192, 2, v192
  v_add_u32 v193, 163104, v192
  ds_read_b32 v196, v193
  s_waitcnt lgkmcnt(0)
  s_mov_b32 s96, 0
  v_readlane_b32 s97, v196, 0
  v_writelane_b32 v199, s96, 0
  s_nop 0
  s_add_u32 s98, s96, s97
  v_writelane_b32 v198, s98, 0
  s_add_u32 s96, s98, 31
  s_and_b32 s96, s96, 0xffffffe0
  s_lshr_b32 s38, s96, 5
  v_readlane_b32 s97, v196, 1
  v_writelane_b32 v199, s96, 1
  s_nop 0
  s_add_u32 s98, s96, s97
  v_writelane_b32 v198, s98, 1
  s_add_u32 s96, s98, 31
  s_and_b32 s96, s96, 0xffffffe0
  s_lshr_b32 s39, s96, 5
  v_readlane_b32 s97, v196, 2
  v_writelane_b32 v199, s96, 2
  s_nop 0
  s_add_u32 s98, s96, s97
  v_writelane_b32 v198, s98, 2
  s_add_u32 s96, s98, 31
  s_and_b32 s96, s96, 0xffffffe0
  s_lshr_b32 s40, s96, 5
  v_readlane_b32 s97, v196, 3
  v_writelane_b32 v199, s96, 3
  s_nop 0
  s_add_u32 s98, s96, s97
  v_writelane_b32 v198, s98, 3
  s_add_u32 s96, s98, 31
  s_and_b32 s96, s96, 0xffffffe0
  s_lshr_b32 s41, s96, 5
  v_readlane_b32 s97, v196, 4
  v_writelane_b32 v199, s96, 4
  s_nop 0
  s_add_u32 s98, s96, s97
  v_writelane_b32 v198, s98, 4
  s_add_u32 s96, s98, 31
  s_and_b32 s96, s96, 0xffffffe0
  s_lshr_b32 s42, s96, 5
  v_readlane_b32 s97, v196, 5
  v_writelane_b32 v199, s96, 5
  s_nop 0
  s_add_u32 s98, s96, s97
  v_writelane_b32 v198, s98, 5
  s_add_u32 s96, s98, 31
  s_and_b32 s96, s96, 0xffffffe0
  s_lshr_b32 s43, s96, 5
  v_readlane_b32 s97, v196, 6
  v_writelane_b32 v199, s96, 6
  s_nop 0
  s_add_u32 s98, s96, s97
  v_writelane_b32 v198, s98, 6
  s_add_u32 s96, s98, 31
  s_and_b32 s96, s96, 0xffffffe0
  s_lshr_b32 s44, s96, 5
  s_mov_b32 s46, s44
  v_cmp_gt_u32 vcc, 8, v1
  v_add_u32 v193, 163136, v192
  s_nop 0
  s_mov_b64 exec, vcc
  ds_write_b32 v193, v199
  s_mov_b64 exec, -1
  v_mov_b32 v200, 0
  v_cmp_le_u32 vcc, s38, v1
  s_nop 1
  v_addc_co_u32 v200, vcc, 0, v200, vcc
  v_cmp_le_u32 vcc, s39, v1
  s_nop 1
  v_addc_co_u32 v200, vcc, 0, v200, vcc
  v_cmp_le_u32 vcc, s40, v1
  s_nop 1
  v_addc_co_u32 v200, vcc, 0, v200, vcc
  v_cmp_le_u32 vcc, s41, v1
  s_nop 1
  v_addc_co_u32 v200, vcc, 0, v200, vcc
  v_cmp_le_u32 vcc, s42, v1
  s_nop 1
  v_addc_co_u32 v200, vcc, 0, v200, vcc
  v_cmp_le_u32 vcc, s43, v1
  s_nop 1
  v_addc_co_u32 v200, vcc, 0, v200, vcc
  v_lshlrev_b32 v201, 2, v200
  ds_bpermute_b32 v201, v201, v198
  v_lshlrev_b32 v202, 5, v1
  s_mov_b32 s59, 163136
  s_mov_b32 s60, 65536
  s_mov_b32 s61, 97792
  v_bfe_u32 v193, v128, 3, 3
  v_lshl_add_u32 v193, v193, 2, s59
  ds_read_b32 v160, v193
  v_bfe_u32 v193, v129, 3, 3
  v_lshl_add_u32 v193, v193, 2, s59
  ds_read_b32 v161, v193
  v_bfe_u32 v193, v130, 3, 3
  v_lshl_add_u32 v193, v193, 2, s59
  ds_read_b32 v162, v193
  v_bfe_u32 v193, v131, 3, 3
  v_lshl_add_u32 v193, v193, 2, s59
  ds_read_b32 v163, v193
  s_waitcnt vmcnt(0) lgkmcnt(0)
  s_cmp_lg_u32 s4, 0
  s_cbranch_scc1 K2_nowx
  v_lshlrev_b32 v44, 16, v44
  v_lshlrev_b32 v45, 16, v45
  v_lshlrev_b32 v46, 16, v46
  v_lshlrev_b32 v47, 16, v47
K2_nowx:
  v_sub_u32 v201, v201, v202
  v_min_u32 v201, 32, v201
  v_lshl_or_b32 v58, v201, 8, v200
  v_add_u32 v194, v160, v144
  v_and_b32 v195, 0xffffff07, v128
  v_lshl_add_u32 v192, v194, 4, s60
  v_lshl_add_u32 v193, v194, 2, s61
  s_mov_b64 exec, s[64:65]
  ds_write_b128 v192, v[64:67]
  ds_write_b32 v193, v195
  s_mov_b64 exec, -1
  v_add_u32 v194, v161, v145
  v_and_b32 v195, 0xffffff07, v129
  v_lshl_add_u32 v192, v194, 4, s60
  v_lshl_add_u32 v193, v194, 2, s61
  s_mov_b64 exec, s[66:67]
  ds_write_b128 v192, v[68:71]
  ds_write_b32 v193, v195
  s_mov_b64 exec, -1
  v_add_u32 v194, v162, v146
  v_and_b32 v195, 0xffffff07, v130
  v_lshl_add_u32 v192, v194, 4, s60
  v_lshl_add_u32 v193, v194, 2, s61
  s_mov_b64 exec, s[68:69]
  ds_write_b128 v192, v[72:75]
  ds_write_b32 v193, v195
  s_mov_b64 exec, -1
  v_add_u32 v194, v163, v147
  v_and_b32 v195, 0xffffff07, v131
  v_lshl_add_u32 v192, v194, 4, s60
  v_lshl_add_u32 v193, v194, 2, s61
  s_mov_b64 exec, s[70:71]
  ds_write_b128 v192, v[76:79]
  ds_write_b32 v193, v195
  s_mov_b64 exec, -1
  s_cmp_ge_u32 s36, 7
  s_cbranch_scc1 K2_nopad
  v_readlane_b32 s96, v198, s36
  s_nop 1
  s_add_u32 s97, s96, 31
  s_and_b32 s97, s97, 0xffffffe0
  v_add_u32 v194, s96, v1
  v_cmp_gt_u32 vcc, s97, v194
  s_nop 1
  s_and_saveexec_b64 s[62:63], vcc
  s_cbranch_execz K2_nopad2
  v_lshl_add_u32 v192, v194, 4, s60
  ds_write_b128 v192, v[60:63]
  v_lshl_add_u32 v192, v194, 2, s61
  ds_write_b32 v192, v60
K2_nopad2:
  s_mov_b64 exec, s[62:63]
K2_nopad:
  s_waitcnt vmcnt(0) lgkmcnt(0)
  s_barrier
  s_mul_i32 s59, s46, s36
  s_lshr_b32 s47, s59, 3
  s_add_u32 s59, s59, s46
  s_lshr_b32 s48, s59, 3
  s_cmp_ge_u32 s47, s48
  s_cbranch_scc1 K2_MAINDONE
  v_readlane_b32 s59, v58, s47
  s_nop 1
  s_and_b32 s49, s59, 0xff
  s_lshr_b32 s50, s59, 8
  s_lshl_b32 s59, s47, 7
  s_lshl_b32 s60, s47, 9
  v_add_u32 v240, s59, v53
  v_add_u32 v241, s59, v54
  v_add_u32 v242, s60, v55
  ds_read_b128 v[228:231], v240
  ds_read_b128 v[232:235], v240 offset:16
  ds_read_b32 v236, v241
  ds_read_b32 v237, v242
  ds_write_b128 v50, v[60:63]
  ds_write_b128 v50, v[60:63] offset:1024
  s_waitcnt lgkmcnt(0)
  v_and_or_b32 v228, v228, s58, v12
  s_add_u32 m0, s55, 0
  v_and_or_b32 v229, v229, s58, v13
  buffer_load_dwordx4 v228, s[16:19], 0 offen lds
  s_add_u32 m0, s55, 1024
  v_and_or_b32 v230, v230, s58, v14
  buffer_load_dwordx4 v229, s[16:19], 0 offen lds
  s_add_u32 m0, s55, 2048
  v_and_or_b32 v231, v231, s58, v15
  buffer_load_dwordx4 v230, s[16:19], 0 offen lds
  s_add_u32 m0, s55, 3072
  v_and_or_b32 v232, v232, s58, v16
  buffer_load_dwordx4 v231, s[16:19], 0 offen lds
  s_add_u32 m0, s55, 4096
  v_and_or_b32 v233, v233, s58, v17
  buffer_load_dwordx4 v232, s[16:19], 0 offen lds
  s_add_u32 m0, s55, 5120
  v_and_or_b32 v234, v234, s58, v18
  buffer_load_dwordx4 v233, s[16:19], 0 offen lds
  s_add_u32 m0, s55, 6144
  v_and_or_b32 v235, v235, s58, v19
  buffer_load_dwordx4 v234, s[16:19], 0 offen lds
  s_add_u32 m0, s55, 7168
  s_nop 0
  buffer_load_dwordx4 v235, s[16:19], 0 offen lds
  v_and_b32 v240, 7, v236
  s_mov_b32 s59, 162976
  v_lshl_add_u32 v241, v240, 4, s59
  s_lshl_b32 s60, s47, 9
  v_add_u32 v242, s60, v56
  v_cndmask_b32 v238, v241, v242, s[56:57]
  v_lshl_add_u32 v239, v240, 8, v49
  v_and_or_b32 v237, v237, v51, v52
  v_cmp_gt_u32 vcc, s50, v2
  s_nop 1
  s_mov_b64 exec, vcc
  ds_write_b16 v239, v237
  ds_write_b16_d16_hi v239, v237 offset:64
  s_mov_b64 exec, -1
  s_lshl_b32 s59, s49, 11
  s_add_u32 s59, s59, 148640
  v_lshlrev_b32 v240, 4, v2
  v_add_u32 v240, s59, v240
  s_mov_b64 exec, 0xffffffff
  ds_read_b128 v[28:31], v240 offset:0
  ds_read_b128 v[32:35], v240 offset:512
  ds_read_b128 v[36:39], v240 offset:1024
  ds_read_b128 v[40:43], v240 offset:1536
  s_mov_b64 exec, -1
  v_pk_mov_b32 v[64:65], 0, 0
  v_pk_mov_b32 v[66:67], 0, 0
  v_pk_mov_b32 v[68:69], 0, 0
  v_pk_mov_b32 v[70:71], 0, 0
  v_pk_mov_b32 v[72:73], 0, 0
  v_pk_mov_b32 v[74:75], 0, 0
  v_pk_mov_b32 v[76:77], 0, 0
  v_pk_mov_b32 v[78:79], 0, 0
  v_pk_mov_b32 v[80:81], 0, 0
  v_pk_mov_b32 v[82:83], 0, 0
  v_pk_mov_b32 v[84:85], 0, 0
  v_pk_mov_b32 v[86:87], 0, 0
  v_pk_mov_b32 v[88:89], 0, 0
  v_pk_mov_b32 v[90:91], 0, 0
  v_pk_mov_b32 v[92:93], 0, 0
  v_pk_mov_b32 v[94:95], 0, 0
  v_pk_mov_b32 v[96:97], 0, 0
  v_pk_mov_b32 v[98:99], 0, 0
  v_pk_mov_b32 v[100:101], 0, 0
  v_pk_mov_b32 v[102:103], 0, 0
  v_pk_mov_b32 v[104:105], 0, 0
  v_pk_mov_b32 v[106:107], 0, 0
  v_pk_mov_b32 v[108:109], 0, 0
  v_pk_mov_b32 v[110:111], 0, 0
  v_pk_mov_b32 v[112:113], 0, 0
  v_pk_mov_b32 v[114:115], 0, 0
  v_pk_mov_b32 v[116:117], 0, 0
  v_pk_mov_b32 v[118:119], 0, 0
  v_pk_mov_b32 v[120:121], 0, 0
  v_pk_mov_b32 v[122:123], 0, 0
  v_pk_mov_b32 v[124:125], 0, 0
  v_pk_mov_b32 v[126:127], 0, 0
  s_waitcnt vmcnt(0)
  ds_read_b128 v[128:131], v4
  ds_read_b128 v[132:135], v5
  ds_read_b128 v[136:139], v6
  ds_read_b128 v[140:143], v7
  ds_read_b128 v[144:147], v8
  ds_read_b128 v[148:151], v9
  ds_read_b128 v[152:155], v10
  ds_read_b128 v[156:159], v11
  ds_read_b128 v[216:219], v238
  ds_read_b128 v[220:223], v48
  ds_read_b128 v[224:227], v48 offset:32
  s_add_u32 s51, s47, 1
  s_cmp_ge_u32 s51, s48
  s_cbranch_scc1 K2_I1
  v_readlane_b32 s59, v58, s51
  s_nop 1
  s_lshr_b32 s50, s59, 8
  s_lshl_b32 s59, s51, 7
  s_lshl_b32 s60, s51, 9
  v_add_u32 v240, s59, v53
  v_add_u32 v241, s59, v54
  v_add_u32 v242, s60, v55
  ds_read_b128 v[228:231], v240
  ds_read_b128 v[232:235], v240 offset:16
  ds_read_b32 v236, v241
  ds_read_b32 v237, v242
  s_waitcnt lgkmcnt(4)
  ds_write_b128 v50, v[60:63]
  ds_write_b128 v50, v[60:63] offset:1024
  s_waitcnt lgkmcnt(2)
  v_and_or_b32 v228, v228, s58, v12
  s_add_u32 m0, s55, 0
  v_and_or_b32 v229, v229, s58, v13
  buffer_load_dwordx4 v228, s[16:19], 0 offen lds
  s_add_u32 m0, s55, 1024
  v_and_or_b32 v230, v230, s58, v14
  buffer_load_dwordx4 v229, s[16:19], 0 offen lds
  s_add_u32 m0, s55, 2048
  v_and_or_b32 v231, v231, s58, v15
  buffer_load_dwordx4 v230, s[16:19], 0 offen lds
  s_add_u32 m0, s55, 3072
  v_and_or_b32 v232, v232, s58, v16
  buffer_load_dwordx4 v231, s[16:19], 0 offen lds
  s_add_u32 m0, s55, 4096
  v_and_or_b32 v233, v233, s58, v17
  buffer_load_dwordx4 v232, s[16:19], 0 offen lds
  s_add_u32 m0, s55, 5120
  v_and_or_b32 v234, v234, s58, v18
  buffer_load_dwordx4 v233, s[16:19], 0 offen lds
  s_add_u32 m0, s55, 6144
  v_and_or_b32 v235, v235, s58, v19
  buffer_load_dwordx4 v234, s[16:19], 0 offen lds
  s_add_u32 m0, s55, 7168
  s_nop 0
  buffer_load_dwordx4 v235, s[16:19], 0 offen lds
  v_and_b32 v240, 7, v236
  s_mov_b32 s59, 162976
  v_lshl_add_u32 v241, v240, 4, s59
  s_lshl_b32 s60, s51, 9
  v_add_u32 v242, s60, v56
  v_cndmask_b32 v238, v241, v242, s[56:57]
  v_lshl_add_u32 v239, v240, 8, v49
  v_and_or_b32 v237, v237, v51, v52
  v_cmp_gt_u32 vcc, s50, v2
  s_nop 1
  s_mov_b64 exec, vcc
  ds_write_b16 v239, v237
  ds_write_b16_d16_hi v239, v237 offset:64
  s_mov_b64 exec, -1
K2_I1:
  s_waitcnt lgkmcnt(0)
  v_mfma_f32_32x32x16_bf16 v[160:175], v[216:219], v[28:31], 0
  v_mfma_f32_32x32x16_bf16 v[160:175], v[128:131], v[20:23], v[160:175]
  v_mfma_f32_32x32x16_bf16 v[160:175], v[132:135], v[24:27], v[160:175]
K2_LOOP:
  s_add_u32 s51, s47, 1
  s_cmp_lt_u32 s51, s48
  s_cselect_b32 s54, 1, 0
  s_min_u32 s59, s51, 63
  v_readlane_b32 s59, v58, s59
  s_add_u32 s62, s47, 2
  s_cmp_lt_u32 s62, s48
  s_cselect_b32 s61, 1, 0
  s_min_u32 s62, s62, 63
  v_readlane_b32 s60, v58, s62
  s_and_b32 s52, s59, 0xff
  s_nop 0
  s_lshr_b32 s53, s60, 8
  s_sub_u32 s62, s48, s47
  s_cmp_ge_u32 s62, 6
  s_cbranch_scc1 K2_P3
  s_cmp_ge_u32 s62, 4
  s_cbranch_scc1 K2_P2
  s_cmp_ge_u32 s62, 2
  s_cbranch_scc1 K2_P1
  s_setprio 0
  s_branch K2_PD
K2_P1:
  s_setprio 1
  s_branch K2_PD
K2_P2:
  s_setprio 2
  s_branch K2_PD
K2_P3:
  s_setprio 3
K2_PD:
  v_exp_f32 v192, v160
  v_mfma_f32_32x32x16_bf16 v[176:191], v[216:219], v[32:35], 0
  v_exp_f32 v193, v161
  v_exp_f32 v194, v162
  v_exp_f32 v195, v163
  v_exp_f32 v196, v164
  v_mfma_f32_32x32x16_bf16 v[176:191], v[136:139], v[20:23], v[176:191]
  v_exp_f32 v197, v165
  v_exp_f32 v198, v166
  v_exp_f32 v199, v167
  v_exp_f32 v200, v168
  v_mfma_f32_32x32x16_bf16 v[176:191], v[140:143], v[24:27], v[176:191]
  v_exp_f32 v201, v169
  v_exp_f32 v202, v170
  v_exp_f32 v203, v171
  v_exp_f32 v204, v172
  v_exp_f32 v205, v173
  v_exp_f32 v206, v174
  v_exp_f32 v207, v175
  v_pk_add_f32 v[192:193], v[192:193], 1.0 op_sel_hi:[1,0]
  v_pk_add_f32 v[194:195], v[194:195], 1.0 op_sel_hi:[1,0]
  v_pk_add_f32 v[196:197], v[196:197], 1.0 op_sel_hi:[1,0]
  v_pk_add_f32 v[198:199], v[198:199], 1.0 op_sel_hi:[1,0]
  v_pk_add_f32 v[200:201], v[200:201], 1.0 op_sel_hi:[1,0]
  v_pk_add_f32 v[202:203], v[202:203], 1.0 op_sel_hi:[1,0]
  v_pk_add_f32 v[204:205], v[204:205], 1.0 op_sel_hi:[1,0]
  v_pk_add_f32 v[206:207], v[206:207], 1.0 op_sel_hi:[1,0]
  v_rcp_f32 v192, v192
  v_rcp_f32 v193, v193
  v_rcp_f32 v194, v194
  v_rcp_f32 v195, v195
  v_rcp_f32 v196, v196
  v_rcp_f32 v197, v197
  v_rcp_f32 v198, v198
  v_rcp_f32 v199, v199
  v_rcp_f32 v200, v200
  v_rcp_f32 v201, v201
  v_rcp_f32 v202, v202
  v_rcp_f32 v203, v203
  v_rcp_f32 v204, v204
  v_rcp_f32 v205, v205
  v_rcp_f32 v206, v206
  v_rcp_f32 v207, v207
  v_pk_mul_f32 v[192:193], v[160:161], v[192:193]
  v_pk_mul_f32 v[194:195], v[162:163], v[194:195]
  v_pk_mul_f32 v[196:197], v[164:165], v[196:197]
  v_pk_mul_f32 v[198:199], v[166:167], v[198:199]
  v_pk_mul_f32 v[200:201], v[168:169], v[200:201]
  v_pk_mul_f32 v[202:203], v[170:171], v[202:203]
  v_pk_mul_f32 v[204:205], v[172:173], v[204:205]
  v_pk_mul_f32 v[206:207], v[174:175], v[206:207]
  v_cvt_pk_bf16_f32 v208, v192, v193
  v_cvt_pk_bf16_f32 v209, v194, v195
  v_cvt_pk_bf16_f32 v210, v196, v197
  v_cvt_pk_bf16_f32 v211, v198, v199
  v_cvt_pk_bf16_f32 v212, v200, v201
  v_cvt_pk_bf16_f32 v213, v202, v203
  v_cvt_pk_bf16_f32 v214, v204, v205
  v_cvt_pk_bf16_f32 v215, v206, v207
  v_exp_f32 v192, v176
  v_mfma_f32_32x32x16_bf16 v[64:79], v[220:223], v[208:211], v[64:79]
  v_exp_f32 v193, v177
  v_exp_f32 v194, v178
  v_exp_f32 v195, v179
  v_exp_f32 v196, v180
  v_mfma_f32_32x32x16_bf16 v[64:79], v[224:227], v[212:215], v[64:79]
  v_exp_f32 v197, v181
  v_exp_f32 v198, v182
  v_exp_f32 v199, v183
  v_exp_f32 v200, v184
  v_mfma_f32_32x32x16_bf16 v[160:175], v[216:219], v[36:39], 0
  v_exp_f32 v201, v185
  v_exp_f32 v202, v186
  v_exp_f32 v203, v187
  v_exp_f32 v204, v188
  v_mfma_f32_32x32x16_bf16 v[160:175], v[144:147], v[20:23], v[160:175]
  v_exp_f32 v205, v189
  v_exp_f32 v206, v190
  v_exp_f32 v207, v191
  v_pk_add_f32 v[192:193], v[192:193], 1.0 op_sel_hi:[1,0]
  v_pk_add_f32 v[194:195], v[194:195], 1.0 op_sel_hi:[1,0]
  v_pk_add_f32 v[196:197], v[196:197], 1.0 op_sel_hi:[1,0]
  v_pk_add_f32 v[198:199], v[198:199], 1.0 op_sel_hi:[1,0]
  v_pk_add_f32 v[200:201], v[200:201], 1.0 op_sel_hi:[1,0]
  v_pk_add_f32 v[202:203], v[202:203], 1.0 op_sel_hi:[1,0]
  v_pk_add_f32 v[204:205], v[204:205], 1.0 op_sel_hi:[1,0]
  v_pk_add_f32 v[206:207], v[206:207], 1.0 op_sel_hi:[1,0]
  v_rcp_f32 v192, v192
  v_mfma_f32_32x32x16_bf16 v[160:175], v[148:151], v[24:27], v[160:175]
  v_rcp_f32 v193, v193
  v_rcp_f32 v194, v194
  v_rcp_f32 v195, v195
  v_rcp_f32 v196, v196
  v_rcp_f32 v197, v197
  v_rcp_f32 v198, v198
  v_rcp_f32 v199, v199
  s_cmp_eq_u32 s61, 0
  s_cbranch_scc1 K2_pr_5
  s_add_u32 s62, s47, 2
  s_lshl_b32 s59, s62, 7
  s_lshl_b32 s60, s62, 9
  v_add_u32 v240, s59, v53
  v_add_u32 v241, s59, v54
  v_add_u32 v242, s60, v55
  ds_read_b128 v[228:231], v240
  ds_read_b128 v[232:235], v240 offset:16
  ds_read_b32 v236, v241
  ds_read_b32 v237, v242
K2_pr_5:
  v_rcp_f32 v200, v200
  v_rcp_f32 v201, v201
  v_rcp_f32 v202, v202
  v_rcp_f32 v203, v203
  v_rcp_f32 v204, v204
  v_rcp_f32 v205, v205
  v_rcp_f32 v206, v206
  v_rcp_f32 v207, v207
  v_pk_mul_f32 v[192:193], v[176:177], v[192:193]
  v_pk_mul_f32 v[194:195], v[178:179], v[194:195]
  v_pk_mul_f32 v[196:197], v[180:181], v[196:197]
  v_pk_mul_f32 v[198:199], v[182:183], v[198:199]
  v_pk_mul_f32 v[200:201], v[184:185], v[200:201]
  v_pk_mul_f32 v[202:203], v[186:187], v[202:203]
  v_pk_mul_f32 v[204:205], v[188:189], v[204:205]
  v_pk_mul_f32 v[206:207], v[190:191], v[206:207]
  v_cvt_pk_bf16_f32 v208, v192, v193
  v_cvt_pk_bf16_f32 v209, v194, v195
  v_cvt_pk_bf16_f32 v210, v196, v197
  v_cvt_pk_bf16_f32 v211, v198, v199
  v_cvt_pk_bf16_f32 v212, v200, v201
  v_cvt_pk_bf16_f32 v213, v202, v203
  v_cvt_pk_bf16_f32 v214, v204, v205
  v_cvt_pk_bf16_f32 v215, v206, v207
  v_exp_f32 v192, v160
  v_mfma_f32_32x32x16_bf16 v[80:95], v[220:223], v[208:211], v[80:95]
  v_exp_f32 v193, v161
  v_exp_f32 v194, v162
  v_exp_f32 v195, v163
  v_exp_f32 v196, v164
  v_mfma_f32_32x32x16_bf16 v[80:95], v[224:227], v[212:215], v[80:95]
  v_exp_f32 v197, v165
  v_exp_f32 v198, v166
  v_exp_f32 v199, v167
  v_exp_f32 v200, v168
  v_mfma_f32_32x32x16_bf16 v[176:191], v[216:219], v[40:43], 0
  v_exp_f32 v201, v169
  v_exp_f32 v202, v170
  v_exp_f32 v203, v171
  v_exp_f32 v204, v172
  v_mfma_f32_32x32x16_bf16 v[176:191], v[152:155], v[20:23], v[176:191]
  v_exp_f32 v205, v173
  v_exp_f32 v206, v174
  v_exp_f32 v207, v175
  v_pk_add_f32 v[192:193], v[192:193], 1.0 op_sel_hi:[1,0]
  v_pk_add_f32 v[194:195], v[194:195], 1.0 op_sel_hi:[1,0]
  v_pk_add_f32 v[196:197], v[196:197], 1.0 op_sel_hi:[1,0]
  v_pk_add_f32 v[198:199], v[198:199], 1.0 op_sel_hi:[1,0]
  v_pk_add_f32 v[200:201], v[200:201], 1.0 op_sel_hi:[1,0]
  v_pk_add_f32 v[202:203], v[202:203], 1.0 op_sel_hi:[1,0]
  v_pk_add_f32 v[204:205], v[204:205], 1.0 op_sel_hi:[1,0]
  v_pk_add_f32 v[206:207], v[206:207], 1.0 op_sel_hi:[1,0]
  v_rcp_f32 v192, v192
  v_mfma_f32_32x32x16_bf16 v[176:191], v[156:159], v[24:27], v[176:191]
  v_rcp_f32 v193, v193
  v_rcp_f32 v194, v194
  v_rcp_f32 v195, v195
  v_rcp_f32 v196, v196
  v_rcp_f32 v197, v197
  v_rcp_f32 v198, v198
  v_rcp_f32 v199, v199
  v_rcp_f32 v200, v200
  v_rcp_f32 v201, v201
  v_rcp_f32 v202, v202
  v_rcp_f32 v203, v203
  s_cmp_eq_u32 s54, 0
  s_cbranch_scc1 K2_b2_6
  s_waitcnt vmcnt(0)
  ds_read_b128 v[128:131], v4
  ds_read_b128 v[132:135], v5
  ds_read_b128 v[136:139], v6
  ds_read_b128 v[140:143], v7
  ds_read_b128 v[144:147], v8
  ds_read_b128 v[148:151], v9
  ds_read_b128 v[152:155], v10
  ds_read_b128 v[156:159], v11
  ds_read_b128 v[216:219], v238
  ds_read_b128 v[244:247], v48
  ds_read_b128 v[248:251], v48 offset:32
K2_b2_6:
  v_rcp_f32 v204, v204
  v_rcp_f32 v205, v205
  v_rcp_f32 v206, v206
  v_rcp_f32 v207, v207
  v_pk_mul_f32 v[192:193], v[160:161], v[192:193]
  v_pk_mul_f32 v[194:195], v[162:163], v[194:195]
  v_pk_mul_f32 v[196:197], v[164:165], v[196:197]
  v_pk_mul_f32 v[198:199], v[166:167], v[198:199]
  v_pk_mul_f32 v[200:201], v[168:169], v[200:201]
  v_pk_mul_f32 v[202:203], v[170:171], v[202:203]
  v_pk_mul_f32 v[204:205], v[172:173], v[204:205]
  v_pk_mul_f32 v[206:207], v[174:175], v[206:207]
  v_cvt_pk_bf16_f32 v208, v192, v193
  v_cvt_pk_bf16_f32 v209, v194, v195
  s_cmp_eq_u32 s61, 0
  s_cbranch_scc1 K2_dm_7
  s_waitcnt lgkmcnt(0)
  ds_write_b128 v50, v[60:63]
  ds_write_b128 v50, v[60:63] offset:1024
  s_add_u32 s62, s47, 2
  v_and_or_b32 v228, v228, s58, v12
  s_add_u32 m0, s55, 0
  v_and_or_b32 v229, v229, s58, v13
  buffer_load_dwordx4 v228, s[16:19], 0 offen lds
  s_add_u32 m0, s55, 1024
  v_and_or_b32 v230, v230, s58, v14
  buffer_load_dwordx4 v229, s[16:19], 0 offen lds
  s_add_u32 m0, s55, 2048
  v_and_or_b32 v231, v231, s58, v15
  buffer_load_dwordx4 v230, s[16:19], 0 offen lds
  s_add_u32 m0, s55, 3072
  v_and_or_b32 v232, v232, s58, v16
  buffer_load_dwordx4 v231, s[16:19], 0 offen lds
  s_add_u32 m0, s55, 4096
  v_and_or_b32 v233, v233, s58, v17
  buffer_load_dwordx4 v232, s[16:19], 0 offen lds
  s_add_u32 m0, s55, 5120
  v_and_or_b32 v234, v234, s58, v18
  buffer_load_dwordx4 v233, s[16:19], 0 offen lds
  s_add_u32 m0, s55, 6144
  v_and_or_b32 v235, v235, s58, v19
  buffer_load_dwordx4 v234, s[16:19], 0 offen lds
  s_add_u32 m0, s55, 7168
  s_nop 0
  buffer_load_dwordx4 v235, s[16:19], 0 offen lds
  v_and_b32 v240, 7, v236
  s_mov_b32 s59, 162976
  v_lshl_add_u32 v241, v240, 4, s59
  s_lshl_b32 s60, s62, 9
  v_add_u32 v242, s60, v56
  v_cndmask_b32 v238, v241, v242, s[56:57]
  v_lshl_add_u32 v239, v240, 8, v49
  v_and_or_b32 v237, v237, v51, v52
  v_cmp_gt_u32 vcc, s53, v2
  s_nop 1
  s_mov_b64 exec, vcc
  ds_write_b16 v239, v237
  ds_write_b16_d16_hi v239, v237 offset:64
  s_mov_b64 exec, -1
K2_dm_7:
  v_cvt_pk_bf16_f32 v210, v196, v197
  v_cvt_pk_bf16_f32 v211, v198, v199
  v_cvt_pk_bf16_f32 v212, v200, v201
  v_cvt_pk_bf16_f32 v213, v202, v203
  v_cvt_pk_bf16_f32 v214, v204, v205
  v_cvt_pk_bf16_f32 v215, v206, v207
  s_cmp_eq_u32 s54, 0
  s_cbranch_scc1 K2_B3C
  s_cmp_eq_u32 s52, s49
  s_cbranch_scc1 K2_B3B
  s_lshl_b32 s59, s52, 11
  s_add_u32 s59, s59, 148640
  v_lshlrev_b32 v240, 4, v2
  v_add_u32 v240, s59, v240
  s_mov_b64 exec, 0xffffffff
  ds_read_b128 v[28:31], v240 offset:0
  ds_read_b128 v[32:35], v240 offset:512
  ds_read_b128 v[36:39], v240 offset:1024
  ds_read_b128 v[40:43], v240 offset:1536
  s_mov_b64 exec, -1
K2_B3B:
K2_B3C:
  s_waitcnt lgkmcnt(0)
  v_exp_f32 v192, v176
  v_mfma_f32_32x32x16_bf16 v[96:111], v[220:223], v[208:211], v[96:111]
  v_exp_f32 v193, v177
  v_exp_f32 v194, v178
  v_exp_f32 v195, v179
  v_exp_f32 v196, v180
  v_mfma_f32_32x32x16_bf16 v[96:111], v[224:227], v[212:215], v[96:111]
  v_exp_f32 v197, v181
  v_exp_f32 v198, v182
  v_exp_f32 v199, v183
  v_exp_f32 v200, v184
  v_mfma_f32_32x32x16_bf16 v[160:175], v[216:219], v[28:31], 0
  v_exp_f32 v201, v185
  v_exp_f32 v202, v186
  v_exp_f32 v203, v187
  v_exp_f32 v204, v188
  v_mfma_f32_32x32x16_bf16 v[160:175], v[128:131], v[20:23], v[160:175]
  v_exp_f32 v205, v189
  v_exp_f32 v206, v190
  v_exp_f32 v207, v191
  v_pk_add_f32 v[192:193], v[192:193], 1.0 op_sel_hi:[1,0]
  v_pk_add_f32 v[194:195], v[194:195], 1.0 op_sel_hi:[1,0]
  v_pk_add_f32 v[196:197], v[196:197], 1.0 op_sel_hi:[1,0]
  v_pk_add_f32 v[198:199], v[198:199], 1.0 op_sel_hi:[1,0]
  v_pk_add_f32 v[200:201], v[200:201], 1.0 op_sel_hi:[1,0]
  v_pk_add_f32 v[202:203], v[202:203], 1.0 op_sel_hi:[1,0]
  v_pk_add_f32 v[204:205], v[204:205], 1.0 op_sel_hi:[1,0]
  v_pk_add_f32 v[206:207], v[206:207], 1.0 op_sel_hi:[1,0]
  v_rcp_f32 v192, v192
  v_mfma_f32_32x32x16_bf16 v[160:175], v[132:135], v[24:27], v[160:175]
  v_rcp_f32 v193, v193
  v_rcp_f32 v194, v194
  v_rcp_f32 v195, v195
  v_rcp_f32 v196, v196
  v_rcp_f32 v197, v197
  v_rcp_f32 v198, v198
  v_rcp_f32 v199, v199
  v_rcp_f32 v200, v200
  v_rcp_f32 v201, v201
  v_rcp_f32 v202, v202
  v_rcp_f32 v203, v203
  v_rcp_f32 v204, v204
  v_rcp_f32 v205, v205
  v_rcp_f32 v206, v206
  v_rcp_f32 v207, v207
  v_pk_mul_f32 v[192:193], v[176:177], v[192:193]
  v_pk_mul_f32 v[194:195], v[178:179], v[194:195]
  v_pk_mul_f32 v[196:197], v[180:181], v[196:197]
  v_pk_mul_f32 v[198:199], v[182:183], v[198:199]
  v_pk_mul_f32 v[200:201], v[184:185], v[200:201]
  v_pk_mul_f32 v[202:203], v[186:187], v[202:203]
  v_pk_mul_f32 v[204:205], v[188:189], v[204:205]
  v_pk_mul_f32 v[206:207], v[190:191], v[206:207]
  v_cvt_pk_bf16_f32 v208, v192, v193
  v_cvt_pk_bf16_f32 v209, v194, v195
  v_cvt_pk_bf16_f32 v210, v196, v197
  v_cvt_pk_bf16_f32 v211, v198, v199
  v_cvt_pk_bf16_f32 v212, v200, v201
  v_cvt_pk_bf16_f32 v213, v202, v203
  v_cvt_pk_bf16_f32 v214, v204, v205
  v_cvt_pk_bf16_f32 v215, v206, v207
  v_mfma_f32_32x32x16_bf16 v[112:127], v[220:223], v[208:211], v[112:127]
  s_nop 0
  v_mfma_f32_32x32x16_bf16 v[112:127], v[224:227], v[212:215], v[112:127]
  s_cmp_eq_u32 s54, 0
  s_cbranch_scc1 K2_FLEND
  v_mov_b32 v220, v244
  v_mov_b32 v221, v245
  v_mov_b32 v222, v246
  v_mov_b32 v223, v247
  v_mov_b32 v224, v248
  v_mov_b32 v225, v249
  v_mov_b32 v226, v250
  v_mov_b32 v227, v251
  s_cmp_eq_u32 s52, s49
  s_cbranch_scc1 K2_NEXT
  v_mul_f32 v192, v44, v65
  v_fmac_f32 v192, v45, v81
  v_fmac_f32 v192, v46, v97
  v_fmac_f32 v192, v47, v113
  v_mul_f32 v193, v44, v66
  v_fmac_f32 v193, v45, v82
  v_fmac_f32 v193, v46, v98
  v_fmac_f32 v193, v47, v114
  v_mul_f32 v194, v44, v67
  v_fmac_f32 v194, v45, v83
  v_fmac_f32 v194, v46, v99
  v_fmac_f32 v194, v47, v115
  v_mul_f32 v195, v44, v69
  v_fmac_f32 v195, v45, v85
  v_fmac_f32 v195, v46, v101
  v_fmac_f32 v195, v47, v117
  v_mul_f32 v196, v44, v70
  v_fmac_f32 v196, v45, v86
  v_fmac_f32 v196, v46, v102
  v_fmac_f32 v196, v47, v118
  v_mul_f32 v197, v44, v71
  v_fmac_f32 v197, v45, v87
  v_fmac_f32 v197, v46, v103
  v_fmac_f32 v197, v47, v119
  v_mul_f32 v198, v44, v73
  v_fmac_f32 v198, v45, v89
  v_fmac_f32 v198, v46, v105
  v_fmac_f32 v198, v47, v121
  v_mul_f32 v199, v44, v74
  v_fmac_f32 v199, v45, v90
  v_fmac_f32 v199, v46, v106
  v_fmac_f32 v199, v47, v122
  v_mul_f32 v200, v44, v75
  v_fmac_f32 v200, v45, v91
  v_fmac_f32 v200, v46, v107
  v_fmac_f32 v200, v47, v123
  v_mul_f32 v201, v44, v77
  v_fmac_f32 v201, v45, v93
  v_fmac_f32 v201, v46, v109
  v_fmac_f32 v201, v47, v125
  v_mul_f32 v202, v44, v78
  v_fmac_f32 v202, v45, v94
  v_fmac_f32 v202, v46, v110
  v_fmac_f32 v202, v47, v126
  v_mul_f32 v203, v44, v79
  v_fmac_f32 v203, v45, v95
  v_fmac_f32 v203, v46, v111
  v_fmac_f32 v203, v47, v127
  v_add_f32_dpp v192, v192, v192 row_shr:1 row_mask:0xf bank_mask:0xf bound_ctrl:0
  v_add_f32_dpp v193, v193, v193 row_shr:1 row_mask:0xf bank_mask:0xf bound_ctrl:0
  v_add_f32_dpp v194, v194, v194 row_shr:1 row_mask:0xf bank_mask:0xf bound_ctrl:0
  v_add_f32_dpp v195, v195, v195 row_shr:1 row_mask:0xf bank_mask:0xf bound_ctrl:0
  v_add_f32_dpp v196, v196, v196 row_shr:1 row_mask:0xf bank_mask:0xf bound_ctrl:0
  v_add_f32_dpp v197, v197, v197 row_shr:1 row_mask:0xf bank_mask:0xf bound_ctrl:0
  v_add_f32_dpp v198, v198, v198 row_shr:1 row_mask:0xf bank_mask:0xf bound_ctrl:0
  v_add_f32_dpp v199, v199, v199 row_shr:1 row_mask:0xf bank_mask:0xf bound_ctrl:0
  v_add_f32_dpp v200, v200, v200 row_shr:1 row_mask:0xf bank_mask:0xf bound_ctrl:0
  v_add_f32_dpp v201, v201, v201 row_shr:1 row_mask:0xf bank_mask:0xf bound_ctrl:0
  v_add_f32_dpp v202, v202, v202 row_shr:1 row_mask:0xf bank_mask:0xf bound_ctrl:0
  v_add_f32_dpp v203, v203, v203 row_shr:1 row_mask:0xf bank_mask:0xf bound_ctrl:0
  v_add_f32_dpp v192, v192, v192 row_shr:2 row_mask:0xf bank_mask:0xf bound_ctrl:0
  v_add_f32_dpp v193, v193, v193 row_shr:2 row_mask:0xf bank_mask:0xf bound_ctrl:0
  v_add_f32_dpp v194, v194, v194 row_shr:2 row_mask:0xf bank_mask:0xf bound_ctrl:0
  v_add_f32_dpp v195, v195, v195 row_shr:2 row_mask:0xf bank_mask:0xf bound_ctrl:0
  v_add_f32_dpp v196, v196, v196 row_shr:2 row_mask:0xf bank_mask:0xf bound_ctrl:0
  v_add_f32_dpp v197, v197, v197 row_shr:2 row_mask:0xf bank_mask:0xf bound_ctrl:0
  v_add_f32_dpp v198, v198, v198 row_shr:2 row_mask:0xf bank_mask:0xf bound_ctrl:0
  v_add_f32_dpp v199, v199, v199 row_shr:2 row_mask:0xf bank_mask:0xf bound_ctrl:0
  v_add_f32_dpp v200, v200, v200 row_shr:2 row_mask:0xf bank_mask:0xf bound_ctrl:0
  v_add_f32_dpp v201, v201, v201 row_shr:2 row_mask:0xf bank_mask:0xf bound_ctrl:0
  v_add_f32_dpp v202, v202, v202 row_shr:2 row_mask:0xf bank_mask:0xf bound_ctrl:0
  v_add_f32_dpp v203, v203, v203 row_shr:2 row_mask:0xf bank_mask:0xf bound_ctrl:0
  v_add_f32_dpp v192, v192, v192 row_shr:4 row_mask:0xf bank_mask:0xf bound_ctrl:0
  v_add_f32_dpp v193, v193, v193 row_shr:4 row_mask:0xf bank_mask:0xf bound_ctrl:0
  v_add_f32_dpp v194, v194, v194 row_shr:4 row_mask:0xf bank_mask:0xf bound_ctrl:0
  v_add_f32_dpp v195, v195, v195 row_shr:4 row_mask:0xf bank_mask:0xf bound_ctrl:0
  v_add_f32_dpp v196, v196, v196 row_shr:4 row_mask:0xf bank_mask:0xf bound_ctrl:0
  v_add_f32_dpp v197, v197, v197 row_shr:4 row_mask:0xf bank_mask:0xf bound_ctrl:0
  v_add_f32_dpp v198, v198, v198 row_shr:4 row_mask:0xf bank_mask:0xf bound_ctrl:0
  v_add_f32_dpp v199, v199, v199 row_shr:4 row_mask:0xf bank_mask:0xf bound_ctrl:0
  v_add_f32_dpp v200, v200, v200 row_shr:4 row_mask:0xf bank_mask:0xf bound_ctrl:0
  v_add_f32_dpp v201, v201, v201 row_shr:4 row_mask:0xf bank_mask:0xf bound_ctrl:0
  v_add_f32_dpp v202, v202, v202 row_shr:4 row_mask:0xf bank_mask:0xf bound_ctrl:0
  v_add_f32_dpp v203, v203, v203 row_shr:4 row_mask:0xf bank_mask:0xf bound_ctrl:0
  v_add_f32_dpp v192, v192, v192 row_shr:8 row_mask:0xf bank_mask:0xf bound_ctrl:0
  v_add_f32_dpp v193, v193, v193 row_shr:8 row_mask:0xf bank_mask:0xf bound_ctrl:0
  v_add_f32_dpp v194, v194, v194 row_shr:8 row_mask:0xf bank_mask:0xf bound_ctrl:0
  v_add_f32_dpp v195, v195, v195 row_shr:8 row_mask:0xf bank_mask:0xf bound_ctrl:0
  v_add_f32_dpp v196, v196, v196 row_shr:8 row_mask:0xf bank_mask:0xf bound_ctrl:0
  v_add_f32_dpp v197, v197, v197 row_shr:8 row_mask:0xf bank_mask:0xf bound_ctrl:0
  v_add_f32_dpp v198, v198, v198 row_shr:8 row_mask:0xf bank_mask:0xf bound_ctrl:0
  v_add_f32_dpp v199, v199, v199 row_shr:8 row_mask:0xf bank_mask:0xf bound_ctrl:0
  v_add_f32_dpp v200, v200, v200 row_shr:8 row_mask:0xf bank_mask:0xf bound_ctrl:0
  v_add_f32_dpp v201, v201, v201 row_shr:8 row_mask:0xf bank_mask:0xf bound_ctrl:0
  v_add_f32_dpp v202, v202, v202 row_shr:8 row_mask:0xf bank_mask:0xf bound_ctrl:0
  v_add_f32_dpp v203, v203, v203 row_shr:8 row_mask:0xf bank_mask:0xf bound_ctrl:0
  v_add_f32_dpp v192, v192, v192 row_bcast:15 row_mask:0xa bank_mask:0xf
  v_add_f32_dpp v193, v193, v193 row_bcast:15 row_mask:0xa bank_mask:0xf
  v_add_f32_dpp v194, v194, v194 row_bcast:15 row_mask:0xa bank_mask:0xf
  v_add_f32_dpp v195, v195, v195 row_bcast:15 row_mask:0xa bank_mask:0xf
  v_add_f32_dpp v196, v196, v196 row_bcast:15 row_mask:0xa bank_mask:0xf
  v_add_f32_dpp v197, v197, v197 row_bcast:15 row_mask:0xa bank_mask:0xf
  v_add_f32_dpp v198, v198, v198 row_bcast:15 row_mask:0xa bank_mask:0xf
  v_add_f32_dpp v199, v199, v199 row_bcast:15 row_mask:0xa bank_mask:0xf
  v_add_f32_dpp v200, v200, v200 row_bcast:15 row_mask:0xa bank_mask:0xf
  v_add_f32_dpp v201, v201, v201 row_bcast:15 row_mask:0xa bank_mask:0xf
  v_add_f32_dpp v202, v202, v202 row_bcast:15 row_mask:0xa bank_mask:0xf
  v_add_f32_dpp v203, v203, v203 row_bcast:15 row_mask:0xa bank_mask:0xf
  s_mul_i32 s59, s49, 4224
  v_add_u32 v240, s59, v57
  v_add_u32 v241, s59, v59
  ds_read_b32 v176, v240 offset:0
  ds_read_b32 v177, v240 offset:1056
  ds_read_b32 v178, v240 offset:2112
  ds_read_b32 v179, v240 offset:3168
  ds_read_b32 v180, v240 offset:128
  ds_read_b32 v181, v240 offset:1184
  ds_read_b32 v182, v240 offset:2240
  ds_read_b32 v183, v240 offset:3296
  ds_read_b32 v184, v240 offset:256
  ds_read_b32 v185, v240 offset:1312
  ds_read_b32 v186, v240 offset:2368
  ds_read_b32 v187, v240 offset:3424
  ds_read_b32 v188, v240 offset:384
  ds_read_b32 v189, v240 offset:1440
  s_waitcnt lgkmcnt(6)
  ds_read_b32 v190, v240 offset:2496
  ds_read_b32 v191, v240 offset:3552
  s_mov_b64 exec, s[14:15]
  ds_read_b32 v208, v241 offset:512
  ds_read_b32 v209, v241 offset:516
  ds_read_b32 v210, v241 offset:520
  ds_read_b32 v211, v241 offset:1568
  ds_read_b32 v212, v241 offset:1572
  ds_read_b32 v213, v241 offset:1576
  ds_read_b32 v214, v241 offset:2624
  ds_read_b32 v215, v241 offset:2628
  ds_read_b32 v228, v241 offset:2632
  ds_read_b32 v229, v241 offset:3680
  ds_read_b32 v230, v241 offset:3684
  ds_read_b32 v231, v241 offset:3688
  s_waitcnt lgkmcnt(0)
  v_add_f32 v208, v208, v192
  v_add_f32 v209, v209, v193
  v_add_f32 v210, v210, v194
  v_add_f32 v211, v211, v195
  v_add_f32 v212, v212, v196
  v_add_f32 v213, v213, v197
  v_add_f32 v214, v214, v198
  v_add_f32 v215, v215, v199
  v_add_f32 v228, v228, v200
  v_add_f32 v229, v229, v201
  v_add_f32 v230, v230, v202
  v_add_f32 v231, v231, v203
  ds_write_b32 v241, v208 offset:512
  ds_write_b32 v241, v209 offset:516
  ds_write_b32 v241, v210 offset:520
  ds_write_b32 v241, v211 offset:1568
  ds_write_b32 v241, v212 offset:1572
  ds_write_b32 v241, v213 offset:1576
  ds_write_b32 v241, v214 offset:2624
  ds_write_b32 v241, v215 offset:2628
  ds_write_b32 v241, v228 offset:2632
  ds_write_b32 v241, v229 offset:3680
  ds_write_b32 v241, v230 offset:3684
  ds_write_b32 v241, v231 offset:3688
  s_mov_b64 exec, -1
  v_add_f32 v176, v176, v64
  v_add_f32 v177, v177, v68
  v_add_f32 v178, v178, v72
  v_add_f32 v179, v179, v76
  v_add_f32 v180, v180, v80
  v_add_f32 v181, v181, v84
  v_add_f32 v182, v182, v88
  v_add_f32 v183, v183, v92
  v_add_f32 v184, v184, v96
  v_add_f32 v185, v185, v100
  v_add_f32 v186, v186, v104
  v_add_f32 v187, v187, v108
  v_add_f32 v188, v188, v112
  v_add_f32 v189, v189, v116
  v_add_f32 v190, v190, v120
  v_add_f32 v191, v191, v124
  s_waitcnt lgkmcnt(2)
  ds_write_b32 v240, v176 offset:0
  ds_write_b32 v240, v177 offset:1056
  ds_write_b32 v240, v178 offset:2112
  ds_write_b32 v240, v179 offset:3168
  ds_write_b32 v240, v180 offset:128
  ds_write_b32 v240, v181 offset:1184
  ds_write_b32 v240, v182 offset:2240
  ds_write_b32 v240, v183 offset:3296
  ds_write_b32 v240, v184 offset:256
  ds_write_b32 v240, v185 offset:1312
  ds_write_b32 v240, v186 offset:2368
  ds_write_b32 v240, v187 offset:3424
  ds_write_b32 v240, v188 offset:384
  ds_write_b32 v240, v189 offset:1440
  ds_write_b32 v240, v190 offset:2496
  ds_write_b32 v240, v191 offset:3552
  s_mov_b32 s49, s52
  v_pk_mov_b32 v[64:65], 0, 0
  v_pk_mov_b32 v[66:67], 0, 0
  v_pk_mov_b32 v[68:69], 0, 0
  v_pk_mov_b32 v[70:71], 0, 0
  v_pk_mov_b32 v[72:73], 0, 0
  v_pk_mov_b32 v[74:75], 0, 0
  v_pk_mov_b32 v[76:77], 0, 0
  v_pk_mov_b32 v[78:79], 0, 0
  v_pk_mov_b32 v[80:81], 0, 0
  v_pk_mov_b32 v[82:83], 0, 0
  v_pk_mov_b32 v[84:85], 0, 0
  v_pk_mov_b32 v[86:87], 0, 0
  v_pk_mov_b32 v[88:89], 0, 0
  v_pk_mov_b32 v[90:91], 0, 0
  v_pk_mov_b32 v[92:93], 0, 0
  v_pk_mov_b32 v[94:95], 0, 0
  v_pk_mov_b32 v[96:97], 0, 0
  v_pk_mov_b32 v[98:99], 0, 0
  v_pk_mov_b32 v[100:101], 0, 0
  v_pk_mov_b32 v[102:103], 0, 0
  v_pk_mov_b32 v[104:105], 0, 0
  v_pk_mov_b32 v[106:107], 0, 0
  v_pk_mov_b32 v[108:109], 0, 0
  v_pk_mov_b32 v[110:111], 0, 0
  v_pk_mov_b32 v[112:113], 0, 0
  v_pk_mov_b32 v[114:115], 0, 0
  v_pk_mov_b32 v[116:117], 0, 0
  v_pk_mov_b32 v[118:119], 0, 0
  v_pk_mov_b32 v[120:121], 0, 0
  v_pk_mov_b32 v[122:123], 0, 0
  v_pk_mov_b32 v[124:125], 0, 0
  v_pk_mov_b32 v[126:127], 0, 0
K2_NEXT:
  s_mov_b32 s47, s51
  s_branch K2_LOOP
K2_FLEND:
  v_mul_f32 v192, v44, v65
  v_fmac_f32 v192, v45, v81
  v_fmac_f32 v192, v46, v97
  s_nop 6
  v_fmac_f32 v192, v47, v113
  v_mul_f32 v193, v44, v66
  v_fmac_f32 v193, v45, v82
  v_fmac_f32 v193, v46, v98
  v_fmac_f32 v193, v47, v114
  v_mul_f32 v194, v44, v67
  v_fmac_f32 v194, v45, v83
  v_fmac_f32 v194, v46, v99
  v_fmac_f32 v194, v47, v115
  v_mul_f32 v195, v44, v69
  v_fmac_f32 v195, v45, v85
  v_fmac_f32 v195, v46, v101
  v_fmac_f32 v195, v47, v117
  v_mul_f32 v196, v44, v70
  v_fmac_f32 v196, v45, v86
  v_fmac_f32 v196, v46, v102
  v_fmac_f32 v196, v47, v118
  v_mul_f32 v197, v44, v71
  v_fmac_f32 v197, v45, v87
  v_fmac_f32 v197, v46, v103
  v_fmac_f32 v197, v47, v119
  v_mul_f32 v198, v44, v73
  v_fmac_f32 v198, v45, v89
  v_fmac_f32 v198, v46, v105
  v_fmac_f32 v198, v47, v121
  v_mul_f32 v199, v44, v74
  v_fmac_f32 v199, v45, v90
  v_fmac_f32 v199, v46, v106
  v_fmac_f32 v199, v47, v122
  v_mul_f32 v200, v44, v75
  v_fmac_f32 v200, v45, v91
  v_fmac_f32 v200, v46, v107
  v_fmac_f32 v200, v47, v123
  v_mul_f32 v201, v44, v77
  v_fmac_f32 v201, v45, v93
  v_fmac_f32 v201, v46, v109
  v_fmac_f32 v201, v47, v125
  v_mul_f32 v202, v44, v78
  v_fmac_f32 v202, v45, v94
  v_fmac_f32 v202, v46, v110
  v_fmac_f32 v202, v47, v126
  v_mul_f32 v203, v44, v79
  v_fmac_f32 v203, v45, v95
  v_fmac_f32 v203, v46, v111
  v_fmac_f32 v203, v47, v127
  v_add_f32_dpp v192, v192, v192 row_shr:1 row_mask:0xf bank_mask:0xf bound_ctrl:0
  v_add_f32_dpp v193, v193, v193 row_shr:1 row_mask:0xf bank_mask:0xf bound_ctrl:0
  v_add_f32_dpp v194, v194, v194 row_shr:1 row_mask:0xf bank_mask:0xf bound_ctrl:0
  v_add_f32_dpp v195, v195, v195 row_shr:1 row_mask:0xf bank_mask:0xf bound_ctrl:0
  v_add_f32_dpp v196, v196, v196 row_shr:1 row_mask:0xf bank_mask:0xf bound_ctrl:0
  v_add_f32_dpp v197, v197, v197 row_shr:1 row_mask:0xf bank_mask:0xf bound_ctrl:0
  v_add_f32_dpp v198, v198, v198 row_shr:1 row_mask:0xf bank_mask:0xf bound_ctrl:0
  v_add_f32_dpp v199, v199, v199 row_shr:1 row_mask:0xf bank_mask:0xf bound_ctrl:0
  v_add_f32_dpp v200, v200, v200 row_shr:1 row_mask:0xf bank_mask:0xf bound_ctrl:0
  v_add_f32_dpp v201, v201, v201 row_shr:1 row_mask:0xf bank_mask:0xf bound_ctrl:0
  v_add_f32_dpp v202, v202, v202 row_shr:1 row_mask:0xf bank_mask:0xf bound_ctrl:0
  v_add_f32_dpp v203, v203, v203 row_shr:1 row_mask:0xf bank_mask:0xf bound_ctrl:0
  v_add_f32_dpp v192, v192, v192 row_shr:2 row_mask:0xf bank_mask:0xf bound_ctrl:0
  v_add_f32_dpp v193, v193, v193 row_shr:2 row_mask:0xf bank_mask:0xf bound_ctrl:0
  v_add_f32_dpp v194, v194, v194 row_shr:2 row_mask:0xf bank_mask:0xf bound_ctrl:0
  v_add_f32_dpp v195, v195, v195 row_shr:2 row_mask:0xf bank_mask:0xf bound_ctrl:0
  v_add_f32_dpp v196, v196, v196 row_shr:2 row_mask:0xf bank_mask:0xf bound_ctrl:0
  v_add_f32_dpp v197, v197, v197 row_shr:2 row_mask:0xf bank_mask:0xf bound_ctrl:0
  v_add_f32_dpp v198, v198, v198 row_shr:2 row_mask:0xf bank_mask:0xf bound_ctrl:0
  v_add_f32_dpp v199, v199, v199 row_shr:2 row_mask:0xf bank_mask:0xf bound_ctrl:0
  v_add_f32_dpp v200, v200, v200 row_shr:2 row_mask:0xf bank_mask:0xf bound_ctrl:0
  v_add_f32_dpp v201, v201, v201 row_shr:2 row_mask:0xf bank_mask:0xf bound_ctrl:0
  v_add_f32_dpp v202, v202, v202 row_shr:2 row_mask:0xf bank_mask:0xf bound_ctrl:0
  v_add_f32_dpp v203, v203, v203 row_shr:2 row_mask:0xf bank_mask:0xf bound_ctrl:0
  v_add_f32_dpp v192, v192, v192 row_shr:4 row_mask:0xf bank_mask:0xf bound_ctrl:0
  v_add_f32_dpp v193, v193, v193 row_shr:4 row_mask:0xf bank_mask:0xf bound_ctrl:0
  v_add_f32_dpp v194, v194, v194 row_shr:4 row_mask:0xf bank_mask:0xf bound_ctrl:0
  v_add_f32_dpp v195, v195, v195 row_shr:4 row_mask:0xf bank_mask:0xf bound_ctrl:0
  v_add_f32_dpp v196, v196, v196 row_shr:4 row_mask:0xf bank_mask:0xf bound_ctrl:0
  v_add_f32_dpp v197, v197, v197 row_shr:4 row_mask:0xf bank_mask:0xf bound_ctrl:0
  v_add_f32_dpp v198, v198, v198 row_shr:4 row_mask:0xf bank_mask:0xf bound_ctrl:0
  v_add_f32_dpp v199, v199, v199 row_shr:4 row_mask:0xf bank_mask:0xf bound_ctrl:0
  v_add_f32_dpp v200, v200, v200 row_shr:4 row_mask:0xf bank_mask:0xf bound_ctrl:0
  v_add_f32_dpp v201, v201, v201 row_shr:4 row_mask:0xf bank_mask:0xf bound_ctrl:0
  v_add_f32_dpp v202, v202, v202 row_shr:4 row_mask:0xf bank_mask:0xf bound_ctrl:0
  v_add_f32_dpp v203, v203, v203 row_shr:4 row_mask:0xf bank_mask:0xf bound_ctrl:0
  v_add_f32_dpp v192, v192, v192 row_shr:8 row_mask:0xf bank_mask:0xf bound_ctrl:0
  v_add_f32_dpp v193, v193, v193 row_shr:8 row_mask:0xf bank_mask:0xf bound_ctrl:0
  v_add_f32_dpp v194, v194, v194 row_shr:8 row_mask:0xf bank_mask:0xf bound_ctrl:0
  v_add_f32_dpp v195, v195, v195 row_shr:8 row_mask:0xf bank_mask:0xf bound_ctrl:0
  v_add_f32_dpp v196, v196, v196 row_shr:8 row_mask:0xf bank_mask:0xf bound_ctrl:0
  v_add_f32_dpp v197, v197, v197 row_shr:8 row_mask:0xf bank_mask:0xf bound_ctrl:0
  v_add_f32_dpp v198, v198, v198 row_shr:8 row_mask:0xf bank_mask:0xf bound_ctrl:0
  v_add_f32_dpp v199, v199, v199 row_shr:8 row_mask:0xf bank_mask:0xf bound_ctrl:0
  v_add_f32_dpp v200, v200, v200 row_shr:8 row_mask:0xf bank_mask:0xf bound_ctrl:0
  v_add_f32_dpp v201, v201, v201 row_shr:8 row_mask:0xf bank_mask:0xf bound_ctrl:0
  v_add_f32_dpp v202, v202, v202 row_shr:8 row_mask:0xf bank_mask:0xf bound_ctrl:0
  v_add_f32_dpp v203, v203, v203 row_shr:8 row_mask:0xf bank_mask:0xf bound_ctrl:0
  v_add_f32_dpp v192, v192, v192 row_bcast:15 row_mask:0xa bank_mask:0xf
  v_add_f32_dpp v193, v193, v193 row_bcast:15 row_mask:0xa bank_mask:0xf
  v_add_f32_dpp v194, v194, v194 row_bcast:15 row_mask:0xa bank_mask:0xf
  v_add_f32_dpp v195, v195, v195 row_bcast:15 row_mask:0xa bank_mask:0xf
  v_add_f32_dpp v196, v196, v196 row_bcast:15 row_mask:0xa bank_mask:0xf
  v_add_f32_dpp v197, v197, v197 row_bcast:15 row_mask:0xa bank_mask:0xf
  v_add_f32_dpp v198, v198, v198 row_bcast:15 row_mask:0xa bank_mask:0xf
  v_add_f32_dpp v199, v199, v199 row_bcast:15 row_mask:0xa bank_mask:0xf
  v_add_f32_dpp v200, v200, v200 row_bcast:15 row_mask:0xa bank_mask:0xf
  v_add_f32_dpp v201, v201, v201 row_bcast:15 row_mask:0xa bank_mask:0xf
  v_add_f32_dpp v202, v202, v202 row_bcast:15 row_mask:0xa bank_mask:0xf
  v_add_f32_dpp v203, v203, v203 row_bcast:15 row_mask:0xa bank_mask:0xf
  s_sub_u32 s59, s55, 122240
  v_add_u32 v240, s59, v57
  v_add_u32 v241, s59, v59
  ds_write_b32 v240, v64 offset:0
  ds_write_b32 v240, v68 offset:1056
  ds_write_b32 v240, v72 offset:2112
  ds_write_b32 v240, v76 offset:3168
  ds_write_b32 v240, v80 offset:128
  ds_write_b32 v240, v84 offset:1184
  ds_write_b32 v240, v88 offset:2240
  ds_write_b32 v240, v92 offset:3296
  ds_write_b32 v240, v96 offset:256
  ds_write_b32 v240, v100 offset:1312
  ds_write_b32 v240, v104 offset:2368
  ds_write_b32 v240, v108 offset:3424
  ds_write_b32 v240, v112 offset:384
  ds_write_b32 v240, v116 offset:1440
  ds_write_b32 v240, v120 offset:2496
  ds_write_b32 v240, v124 offset:3552
  s_mov_b64 exec, s[14:15]
  ds_write_b32 v241, v192 offset:512
  ds_write_b32 v241, v193 offset:516
  ds_write_b32 v241, v194 offset:520
  ds_write_b32 v241, v195 offset:1568
  ds_write_b32 v241, v196 offset:1572
  ds_write_b32 v241, v197 offset:1576
  ds_write_b32 v241, v198 offset:2624
  ds_write_b32 v241, v199 offset:2628
  ds_write_b32 v241, v200 offset:2632
  ds_write_b32 v241, v201 offset:3680
  ds_write_b32 v241, v202 offset:3684
  ds_write_b32 v241, v203 offset:3688
  s_mov_b64 exec, -1
  s_mov_b32 s45, s49
K2_MAINDONE:
  s_setprio 0
  v_mov_b32 v240, s45
  s_lshl_b32 s59, s36, 2
  s_add_u32 s59, s59, 163136
  v_mov_b32 v241, s59
  ds_write_b32 v241, v240
  s_add_u32 s7, s4, 1799
  s_cmp_lt_u32 s7, s5
  s_cbranch_scc1 K2_NOEPI
  s_lshr_b32 s96, s36, 2
  s_and_b32 s97, s36, 3
  v_lshlrev_b32 v4, 4, v1
  s_lshl_b32 s59, s97, 14
  s_add_u32 s59, s59, 15040000
  buffer_load_dwordx4 v[64:67], v4, s[16:19], s59 offen
  s_add_u32 s59, s59, 1024
  buffer_load_dwordx4 v[68:71], v4, s[16:19], s59 offen
  s_add_u32 s59, s59, 1024
  buffer_load_dwordx4 v[72:75], v4, s[16:19], s59 offen
  s_add_u32 s59, s59, 1024
  buffer_load_dwordx4 v[76:79], v4, s[16:19], s59 offen
  s_add_u32 s59, s59, 1024
  buffer_load_dwordx4 v[80:83], v4, s[16:19], s59 offen
  s_add_u32 s59, s59, 1024
  buffer_load_dwordx4 v[84:87], v4, s[16:19], s59 offen
  s_add_u32 s59, s59, 1024
  buffer_load_dwordx4 v[88:91], v4, s[16:19], s59 offen
  s_add_u32 s59, s59, 1024
  buffer_load_dwordx4 v[92:95], v4, s[16:19], s59 offen
  s_add_u32 s59, s59, 1024
  buffer_load_dwordx4 v[96:99], v4, s[16:19], s59 offen
  s_add_u32 s59, s59, 1024
  buffer_load_dwordx4 v[100:103], v4, s[16:19], s59 offen
  s_add_u32 s59, s59, 1024
  buffer_load_dwordx4 v[104:107], v4, s[16:19], s59 offen
  s_add_u32 s59, s59, 1024
  buffer_load_dwordx4 v[108:111], v4, s[16:19], s59 offen
  s_add_u32 s59, s59, 1024
  buffer_load_dwordx4 v[112:115], v4, s[16:19], s59 offen
  s_add_u32 s59, s59, 1024
  buffer_load_dwordx4 v[116:119], v4, s[16:19], s59 offen
  s_add_u32 s59, s59, 1024
  buffer_load_dwordx4 v[120:123], v4, s[16:19], s59 offen
  s_add_u32 s59, s59, 1024
  buffer_load_dwordx4 v[124:127], v4, s[16:19], s59 offen
  s_lshl_b32 s59, s96, 5
  v_add_u32 v5, s59, v2
  v_add_u32 v6, s37, v5
  v_lshlrev_b32 v6, 8, v6
  v_lshl_add_u32 v7, v3, 4, v6
  buffer_load_dwordx4 v[128:131], v7, s[20:23], 0 offen offset:0
  buffer_load_dwordx4 v[132:135], v7, s[20:23], 0 offen offset:32
  buffer_load_dwordx4 v[136:139], v7, s[20:23], 0 offen offset:64
  buffer_load_dwordx4 v[140:143], v7, s[20:23], 0 offen offset:96
  buffer_load_dwordx4 v[144:147], v7, s[20:23], 0 offen offset:128
  buffer_load_dwordx4 v[148:151], v7, s[20:23], 0 offen offset:160
  buffer_load_dwordx4 v[152:155], v7, s[20:23], 0 offen offset:192
  buffer_load_dwordx4 v[156:159], v7, s[20:23], 0 offen offset:224
  v_lshl_add_u32 v7, v3, 3, v6
  s_lshl_b32 s60, s97, 6
  buffer_load_dwordx2 v[160:161], v7, s[20:23], s60 offen offset:0
  buffer_load_dwordx2 v[162:163], v7, s[20:23], s60 offen offset:16
  buffer_load_dwordx2 v[164:165], v7, s[20:23], s60 offen offset:32
  buffer_load_dwordx2 v[166:167], v7, s[20:23], s60 offen offset:48
K2_NOEPI:
  s_waitcnt lgkmcnt(0)
  s_barrier
  v_lshlrev_b32 v240, 4, v0
  v_mov_b32 v241, 163136
  ds_read_b128 v[200:203], v241
  ds_read_b128 v[204:207], v241 offset:16
  v_cmp_gt_u32 vcc, 264, v0
  s_nop 1
  s_and_saveexec_b64 s[62:63], vcc
  s_cbranch_execz K2_red_done
  ds_read_b128 v[168:171], v240 offset:0
  ds_read_b128 v[172:175], v240 offset:8192
  ds_read_b128 v[176:179], v240 offset:16384
  ds_read_b128 v[180:183], v240 offset:24576
  ds_read_b128 v[184:187], v240 offset:32768
  ds_read_b128 v[188:191], v240 offset:40960
  ds_read_b128 v[192:195], v240 offset:49152
  ds_read_b128 v[196:199], v240 offset:57344
  v_mul_u32_u24 v242, 497, v0
  v_lshrrev_b32 v242, 14, v242
  s_waitcnt lgkmcnt(0)
  s_mov_b64 s[12:13], exec
  v_readfirstlane_b32 s100, v200
  s_nop 1
  s_cmp_ge_u32 s100, 7
  s_cbranch_scc1 K2_red_8
  s_lshl_b32 s101, s100, 3
  v_add_u32 v243, s101, v242
  v_cmp_gt_u32 vcc, 50, v243
  s_nop 1
  s_and_b64 exec, s[12:13], vcc
  s_cbranch_execz K2_red_8
  s_mul_i32 s101, s100, 4224
  s_add_u32 s101, s101, 122240
  v_add_u32 v243, s101, v240
  ds_read_b128 v[208:211], v243
  s_waitcnt lgkmcnt(0)
  v_add_f32 v208, v208, v168
  v_add_f32 v209, v209, v169
  v_add_f32 v210, v210, v170
  v_add_f32 v211, v211, v171
  ds_write_b128 v243, v[208:211]
  s_waitcnt lgkmcnt(0)
K2_red_8:
  s_mov_b64 exec, s[12:13]
  v_readfirstlane_b32 s100, v201
  s_nop 1
  s_cmp_ge_u32 s100, 7
  s_cbranch_scc1 K2_red_9
  s_lshl_b32 s101, s100, 3
  v_add_u32 v243, s101, v242
  v_cmp_gt_u32 vcc, 50, v243
  s_nop 1
  s_and_b64 exec, s[12:13], vcc
  s_cbranch_execz K2_red_9
  s_mul_i32 s101, s100, 4224
  s_add_u32 s101, s101, 122240
  v_add_u32 v243, s101, v240
  ds_read_b128 v[208:211], v243
  s_waitcnt lgkmcnt(0)
  v_add_f32 v208, v208, v172
  v_add_f32 v209, v209, v173
  v_add_f32 v210, v210, v174
  v_add_f32 v211, v211, v175
  ds_write_b128 v243, v[208:211]
  s_waitcnt lgkmcnt(0)
K2_red_9:
  s_mov_b64 exec, s[12:13]
  v_readfirstlane_b32 s100, v202
  s_nop 1
  s_cmp_ge_u32 s100, 7
  s_cbranch_scc1 K2_red_10
  s_lshl_b32 s101, s100, 3
  v_add_u32 v243, s101, v242
  v_cmp_gt_u32 vcc, 50, v243
  s_nop 1
  s_and_b64 exec, s[12:13], vcc
  s_cbranch_execz K2_red_10
  s_mul_i32 s101, s100, 4224
  s_add_u32 s101, s101, 122240
  v_add_u32 v243, s101, v240
  ds_read_b128 v[208:211], v243
  s_waitcnt lgkmcnt(0)
  v_add_f32 v208, v208, v176
  v_add_f32 v209, v209, v177
  v_add_f32 v210, v210, v178
  v_add_f32 v211, v211, v179
  ds_write_b128 v243, v[208:211]
  s_waitcnt lgkmcnt(0)
K2_red_10:
  s_mov_b64 exec, s[12:13]
  v_readfirstlane_b32 s100, v203
  s_nop 1
  s_cmp_ge_u32 s100, 7
  s_cbranch_scc1 K2_red_11
  s_lshl_b32 s101, s100, 3
  v_add_u32 v243, s101, v242
  v_cmp_gt_u32 vcc, 50, v243
  s_nop 1
  s_and_b64 exec, s[12:13], vcc
  s_cbranch_execz K2_red_11
  s_mul_i32 s101, s100, 4224
  s_add_u32 s101, s101, 122240
  v_add_u32 v243, s101, v240
  ds_read_b128 v[208:211], v243
  s_waitcnt lgkmcnt(0)
  v_add_f32 v208, v208, v180
  v_add_f32 v209, v209, v181
  v_add_f32 v210, v210, v182
  v_add_f32 v211, v211, v183
  ds_write_b128 v243, v[208:211]
  s_waitcnt lgkmcnt(0)
K2_red_11:
  s_mov_b64 exec, s[12:13]
  v_readfirstlane_b32 s100, v204
  s_nop 1
  s_cmp_ge_u32 s100, 7
  s_cbranch_scc1 K2_red_12
  s_lshl_b32 s101, s100, 3
  v_add_u32 v243, s101, v242
  v_cmp_gt_u32 vcc, 50, v243
  s_nop 1
  s_and_b64 exec, s[12:13], vcc
  s_cbranch_execz K2_red_12
  s_mul_i32 s101, s100, 4224
  s_add_u32 s101, s101, 122240
  v_add_u32 v243, s101, v240
  ds_read_b128 v[208:211], v243
  s_waitcnt lgkmcnt(0)
  v_add_f32 v208, v208, v184
  v_add_f32 v209, v209, v185
  v_add_f32 v210, v210, v186
  v_add_f32 v211, v211, v187
  ds_write_b128 v243, v[208:211]
  s_waitcnt lgkmcnt(0)
K2_red_12:
  s_mov_b64 exec, s[12:13]
  v_readfirstlane_b32 s100, v205
  s_nop 1
  s_cmp_ge_u32 s100, 7
  s_cbranch_scc1 K2_red_13
  s_lshl_b32 s101, s100, 3
  v_add_u32 v243, s101, v242
  v_cmp_gt_u32 vcc, 50, v243
  s_nop 1
  s_and_b64 exec, s[12:13], vcc
  s_cbranch_execz K2_red_13
  s_mul_i32 s101, s100, 4224
  s_add_u32 s101, s101, 122240
  v_add_u32 v243, s101, v240
  ds_read_b128 v[208:211], v243
  s_waitcnt lgkmcnt(0)
  v_add_f32 v208, v208, v188
  v_add_f32 v209, v209, v189
  v_add_f32 v210, v210, v190
  v_add_f32 v211, v211, v191
  ds_write_b128 v243, v[208:211]
  s_waitcnt lgkmcnt(0)
K2_red_13:
  s_mov_b64 exec, s[12:13]
  v_readfirstlane_b32 s100, v206
  s_nop 1
  s_cmp_ge_u32 s100, 7
  s_cbranch_scc1 K2_red_14
  s_lshl_b32 s101, s100, 3
  v_add_u32 v243, s101, v242
  v_cmp_gt_u32 vcc, 50, v243
  s_nop 1
  s_and_b64 exec, s[12:13], vcc
  s_cbranch_execz K2_red_14
  s_mul_i32 s101, s100, 4224
  s_add_u32 s101, s101, 122240
  v_add_u32 v243, s101, v240
  ds_read_b128 v[208:211], v243
  s_waitcnt lgkmcnt(0)
  v_add_f32 v208, v208, v192
  v_add_f32 v209, v209, v193
  v_add_f32 v210, v210, v194
  v_add_f32 v211, v211, v195
  ds_write_b128 v243, v[208:211]
  s_waitcnt lgkmcnt(0)
K2_red_14:
  s_mov_b64 exec, s[12:13]
  v_readfirstlane_b32 s100, v207
  s_nop 1
  s_cmp_ge_u32 s100, 7
  s_cbranch_scc1 K2_red_15
  s_lshl_b32 s101, s100, 3
  v_add_u32 v243, s101, v242
  v_cmp_gt_u32 vcc, 50, v243
  s_nop 1
  s_and_b64 exec, s[12:13], vcc
  s_cbranch_execz K2_red_15
  s_mul_i32 s101, s100, 4224
  s_add_u32 s101, s101, 122240
  v_add_u32 v243, s101, v240
  ds_read_b128 v[208:211], v243
  s_waitcnt lgkmcnt(0)
  v_add_f32 v208, v208, v196
  v_add_f32 v209, v209, v197
  v_add_f32 v210, v210, v198
  v_add_f32 v211, v211, v199
  ds_write_b128 v243, v[208:211]
  s_waitcnt lgkmcnt(0)
K2_red_15:
  s_mov_b64 exec, s[12:13]
K2_red_done:
  s_mov_b64 exec, s[62:63]
  s_waitcnt lgkmcnt(0)
  s_barrier
  s_mov_b32 s4, s7
  s_cmp_lt_u32 s7, s5
  s_cbranch_scc1 K2_ROUND
  v_mul_u32_u24 v8, 528, v5
  v_lshl_add_u32 v8, v3, 5, v8
  v_add_u32 v8, 122240, v8
  s_mov_b32 s61, 0xbf317218
  ds_read_b128 v[184:187], v8 offset:0
  ds_read_b128 v[188:191], v8 offset:16
  ds_read_b128 v[192:195], v8 offset:64
  ds_read_b128 v[196:199], v8 offset:80
  ds_read_b128 v[200:203], v8 offset:128
  ds_read_b128 v[204:207], v8 offset:144
  ds_read_b128 v[208:211], v8 offset:192
  ds_read_b128 v[212:215], v8 offset:208
  ds_read_b128 v[216:219], v8 offset:256
  ds_read_b128 v[220:223], v8 offset:272
  ds_read_b128 v[224:227], v8 offset:320
  ds_read_b128 v[228:231], v8 offset:336
  ds_read_b128 v[232:235], v8 offset:384
  ds_read_b128 v[236:239], v8 offset:400
  s_waitcnt lgkmcnt(8)
  ds_read_b128 v[240:243], v8 offset:448
  ds_read_b128 v[244:247], v8 offset:464
  s_waitcnt lgkmcnt(14)
  v_mul_f32 v184, s61, v184
  v_mul_f32 v185, s61, v185
  v_mul_f32 v186, s61, v186
  v_mul_f32 v187, s61, v187
  v_mul_f32 v188, s61, v188
  v_mul_f32 v189, s61, v189
  v_mul_f32 v190, s61, v190
  v_mul_f32 v191, s61, v191
  v_cvt_pk_bf16_f32 v168, v184, v185
  v_cvt_pk_bf16_f32 v169, v186, v187
  v_cvt_pk_bf16_f32 v170, v188, v189
  v_cvt_pk_bf16_f32 v171, v190, v191
  s_waitcnt lgkmcnt(12)
  v_mul_f32 v192, s61, v192
  v_mul_f32 v193, s61, v193
  v_mul_f32 v194, s61, v194
  v_mul_f32 v195, s61, v195
  v_mul_f32 v196, s61, v196
  v_mul_f32 v197, s61, v197
  v_mul_f32 v198, s61, v198
  v_mul_f32 v199, s61, v199
  v_cvt_pk_bf16_f32 v172, v192, v193
  v_cvt_pk_bf16_f32 v173, v194, v195
  v_cvt_pk_bf16_f32 v174, v196, v197
  v_cvt_pk_bf16_f32 v175, v198, v199
  s_waitcnt lgkmcnt(10)
  v_mul_f32 v200, s61, v200
  v_mul_f32 v201, s61, v201
  v_mul_f32 v202, s61, v202
  v_mul_f32 v203, s61, v203
  v_mul_f32 v204, s61, v204
  v_mul_f32 v205, s61, v205
  v_mul_f32 v206, s61, v206
  v_mul_f32 v207, s61, v207
  v_cvt_pk_bf16_f32 v176, v200, v201
  v_cvt_pk_bf16_f32 v177, v202, v203
  v_cvt_pk_bf16_f32 v178, v204, v205
  v_cvt_pk_bf16_f32 v179, v206, v207
  s_waitcnt lgkmcnt(8)
  v_mul_f32 v208, s61, v208
  v_mul_f32 v209, s61, v209
  v_mul_f32 v210, s61, v210
  v_mul_f32 v211, s61, v211
  v_mul_f32 v212, s61, v212
  v_mul_f32 v213, s61, v213
  v_mul_f32 v214, s61, v214
  v_mul_f32 v215, s61, v215
  v_cvt_pk_bf16_f32 v180, v208, v209
  v_cvt_pk_bf16_f32 v181, v210, v211
  v_cvt_pk_bf16_f32 v182, v212, v213
  v_cvt_pk_bf16_f32 v183, v214, v215
  s_waitcnt lgkmcnt(6)
  v_mul_f32 v216, s61, v216
  v_mul_f32 v217, s61, v217
  v_mul_f32 v218, s61, v218
  v_mul_f32 v219, s61, v219
  v_mul_f32 v220, s61, v220
  v_mul_f32 v221, s61, v221
  v_mul_f32 v222, s61, v222
  v_mul_f32 v223, s61, v223
  v_cvt_pk_bf16_f32 v184, v216, v217
  v_cvt_pk_bf16_f32 v185, v218, v219
  v_cvt_pk_bf16_f32 v186, v220, v221
  v_cvt_pk_bf16_f32 v187, v222, v223
  s_waitcnt lgkmcnt(4)
  v_mul_f32 v224, s61, v224
  v_mul_f32 v225, s61, v225
  v_mul_f32 v226, s61, v226
  v_mul_f32 v227, s61, v227
  v_mul_f32 v228, s61, v228
  v_mul_f32 v229, s61, v229
  v_mul_f32 v230, s61, v230
  v_mul_f32 v231, s61, v231
  v_cvt_pk_bf16_f32 v188, v224, v225
  v_cvt_pk_bf16_f32 v189, v226, v227
  v_cvt_pk_bf16_f32 v190, v228, v229
  v_cvt_pk_bf16_f32 v191, v230, v231
  s_waitcnt lgkmcnt(2)
  v_mul_f32 v232, s61, v232
  v_mul_f32 v233, s61, v233
  v_mul_f32 v234, s61, v234
  v_mul_f32 v235, s61, v235
  v_mul_f32 v236, s61, v236
  v_mul_f32 v237, s61, v237
  v_mul_f32 v238, s61, v238
  v_mul_f32 v239, s61, v239
  v_cvt_pk_bf16_f32 v192, v232, v233
  v_cvt_pk_bf16_f32 v193, v234, v235
  v_cvt_pk_bf16_f32 v194, v236, v237
  v_cvt_pk_bf16_f32 v195, v238, v239
  s_waitcnt lgkmcnt(0)
  v_mul_f32 v240, s61, v240
  v_mul_f32 v241, s61, v241
  v_mul_f32 v242, s61, v242
  v_mul_f32 v243, s61, v243
  v_mul_f32 v244, s61, v244
  v_mul_f32 v245, s61, v245
  v_mul_f32 v246, s61, v246
  v_mul_f32 v247, s61, v247
  v_cvt_pk_bf16_f32 v196, v240, v241
  v_cvt_pk_bf16_f32 v197, v242, v243
  v_cvt_pk_bf16_f32 v198, v244, v245
  v_cvt_pk_bf16_f32 v199, v246, v247
  s_waitcnt vmcnt(0)
  v_mfma_f32_32x32x16_bf16 v[200:215], v[64:67], v[128:131], 0
  v_mfma_f32_32x32x16_bf16 v[200:215], v[68:71], v[132:135], v[200:215]
  v_mfma_f32_32x32x16_bf16 v[200:215], v[72:75], v[136:139], v[200:215]
  v_mfma_f32_32x32x16_bf16 v[200:215], v[76:79], v[140:143], v[200:215]
  v_mfma_f32_32x32x16_bf16 v[200:215], v[80:83], v[144:147], v[200:215]
  v_mfma_f32_32x32x16_bf16 v[200:215], v[84:87], v[148:151], v[200:215]
  v_mfma_f32_32x32x16_bf16 v[200:215], v[88:91], v[152:155], v[200:215]
  v_mfma_f32_32x32x16_bf16 v[200:215], v[92:95], v[156:159], v[200:215]
  v_mfma_f32_32x32x16_bf16 v[200:215], v[96:99], v[168:171], v[200:215]
  v_mfma_f32_32x32x16_bf16 v[200:215], v[100:103], v[172:175], v[200:215]
  v_mfma_f32_32x32x16_bf16 v[200:215], v[104:107], v[176:179], v[200:215]
  v_mfma_f32_32x32x16_bf16 v[200:215], v[108:111], v[180:183], v[200:215]
  v_mfma_f32_32x32x16_bf16 v[200:215], v[112:115], v[184:187], v[200:215]
  v_mfma_f32_32x32x16_bf16 v[200:215], v[116:119], v[188:191], v[200:215]
  v_mfma_f32_32x32x16_bf16 v[200:215], v[120:123], v[192:195], v[200:215]
  v_mfma_f32_32x32x16_bf16 v[200:215], v[124:127], v[196:199], v[200:215]
  s_mov_b32 s62, 0xbfb8aa3b
  s_nop 10
  v_cvt_pk_bf16_f32 v216, v200, v201
  v_cvt_pk_bf16_f32 v217, v202, v203
  v_lshlrev_b32 v200, 16, v216
  v_and_b32 v201, 0xffff0000, v216
  v_lshlrev_b32 v202, 16, v217
  v_and_b32 v203, 0xffff0000, v217
  v_mul_f32 v218, s62, v200
  v_mul_f32 v219, s62, v201
  v_mul_f32 v220, s62, v202
  v_mul_f32 v221, s62, v203
  v_exp_f32 v218, v218
  v_exp_f32 v219, v219
  v_exp_f32 v220, v220
  v_exp_f32 v221, v221
  v_add_f32 v218, 1.0, v218
  v_add_f32 v219, 1.0, v219
  v_add_f32 v220, 1.0, v220
  v_add_f32 v221, 1.0, v221
  v_rcp_f32 v218, v218
  v_rcp_f32 v219, v219
  v_rcp_f32 v220, v220
  v_rcp_f32 v221, v221
  v_mul_f32 v218, v200, v218
  v_mul_f32 v219, v201, v219
  v_mul_f32 v220, v202, v220
  v_mul_f32 v221, v203, v221
  v_cvt_pk_bf16_f32 v216, v218, v219
  v_cvt_pk_bf16_f32 v217, v220, v221
  v_lshlrev_b32 v218, 16, v216
  v_and_b32 v219, 0xffff0000, v216
  v_lshlrev_b32 v220, 16, v217
  v_and_b32 v221, 0xffff0000, v217
  v_lshlrev_b32 v222, 16, v160
  v_and_b32 v223, 0xffff0000, v160
  v_lshlrev_b32 v224, 16, v161
  v_and_b32 v225, 0xffff0000, v161
  v_add_f32 v218, v218, v222
  v_add_f32 v219, v219, v223
  v_add_f32 v220, v220, v224
  v_add_f32 v221, v221, v225
  v_cvt_pk_bf16_f32 v226, v218, v219
  v_cvt_pk_bf16_f32 v227, v220, v221
  v_cvt_pk_bf16_f32 v216, v204, v205
  v_cvt_pk_bf16_f32 v217, v206, v207
  v_lshlrev_b32 v204, 16, v216
  v_and_b32 v205, 0xffff0000, v216
  v_lshlrev_b32 v206, 16, v217
  v_and_b32 v207, 0xffff0000, v217
  v_mul_f32 v218, s62, v204
  v_mul_f32 v219, s62, v205
  v_mul_f32 v220, s62, v206
  v_mul_f32 v221, s62, v207
  v_exp_f32 v218, v218
  v_exp_f32 v219, v219
  v_exp_f32 v220, v220
  v_exp_f32 v221, v221
  v_add_f32 v218, 1.0, v218
  v_add_f32 v219, 1.0, v219
  v_add_f32 v220, 1.0, v220
  v_add_f32 v221, 1.0, v221
  v_rcp_f32 v218, v218
  v_rcp_f32 v219, v219
  v_rcp_f32 v220, v220
  v_rcp_f32 v221, v221
  v_mul_f32 v218, v204, v218
  v_mul_f32 v219, v205, v219
  v_mul_f32 v220, v206, v220
  v_mul_f32 v221, v207, v221
  v_cvt_pk_bf16_f32 v216, v218, v219
  v_cvt_pk_bf16_f32 v217, v220, v221
  v_lshlrev_b32 v218, 16, v216
  v_and_b32 v219, 0xffff0000, v216
  v_lshlrev_b32 v220, 16, v217
  v_and_b32 v221, 0xffff0000, v217
  v_lshlrev_b32 v222, 16, v162
  v_and_b32 v223, 0xffff0000, v162
  v_lshlrev_b32 v224, 16, v163
  v_and_b32 v225, 0xffff0000, v163
  v_add_f32 v218, v218, v222
  v_add_f32 v219, v219, v223
  v_add_f32 v220, v220, v224
  v_add_f32 v221, v221, v225
  v_cvt_pk_bf16_f32 v228, v218, v219
  v_cvt_pk_bf16_f32 v229, v220, v221
  v_cvt_pk_bf16_f32 v216, v208, v209
  v_cvt_pk_bf16_f32 v217, v210, v211
  v_lshlrev_b32 v208, 16, v216
  v_and_b32 v209, 0xffff0000, v216
  v_lshlrev_b32 v210, 16, v217
  v_and_b32 v211, 0xffff0000, v217
  v_mul_f32 v218, s62, v208
  v_mul_f32 v219, s62, v209
  v_mul_f32 v220, s62, v210
  v_mul_f32 v221, s62, v211
  v_exp_f32 v218, v218
  v_exp_f32 v219, v219
  v_exp_f32 v220, v220
  v_exp_f32 v221, v221
  v_add_f32 v218, 1.0, v218
  v_add_f32 v219, 1.0, v219
  v_add_f32 v220, 1.0, v220
  v_add_f32 v221, 1.0, v221
  v_rcp_f32 v218, v218
  v_rcp_f32 v219, v219
  v_rcp_f32 v220, v220
  v_rcp_f32 v221, v221
  v_mul_f32 v218, v208, v218
  v_mul_f32 v219, v209, v219
  v_mul_f32 v220, v210, v220
  v_mul_f32 v221, v211, v221
  v_cvt_pk_bf16_f32 v216, v218, v219
  v_cvt_pk_bf16_f32 v217, v220, v221
  v_lshlrev_b32 v218, 16, v216
  v_and_b32 v219, 0xffff0000, v216
  v_lshlrev_b32 v220, 16, v217
  v_and_b32 v221, 0xffff0000, v217
  v_lshlrev_b32 v222, 16, v164
  v_and_b32 v223, 0xffff0000, v164
  v_lshlrev_b32 v224, 16, v165
  v_and_b32 v225, 0xffff0000, v165
  v_add_f32 v218, v218, v222
  v_add_f32 v219, v219, v223
  v_add_f32 v220, v220, v224
  v_add_f32 v221, v221, v225
  v_cvt_pk_bf16_f32 v230, v218, v219
  v_cvt_pk_bf16_f32 v231, v220, v221
  v_cvt_pk_bf16_f32 v216, v212, v213
  v_cvt_pk_bf16_f32 v217, v214, v215
  v_lshlrev_b32 v212, 16, v216
  v_and_b32 v213, 0xffff0000, v216
  v_lshlrev_b32 v214, 16, v217
  v_and_b32 v215, 0xffff0000, v217
  v_mul_f32 v218, s62, v212
  v_mul_f32 v219, s62, v213
  v_mul_f32 v220, s62, v214
  v_mul_f32 v221, s62, v215
  v_exp_f32 v218, v218
  v_exp_f32 v219, v219
  v_exp_f32 v220, v220
  v_exp_f32 v221, v221
  v_add_f32 v218, 1.0, v218
  v_add_f32 v219, 1.0, v219
  v_add_f32 v220, 1.0, v220
  v_add_f32 v221, 1.0, v221
  v_rcp_f32 v218, v218
  v_rcp_f32 v219, v219
  v_rcp_f32 v220, v220
  v_rcp_f32 v221, v221
  v_mul_f32 v218, v212, v218
  v_mul_f32 v219, v213, v219
  v_mul_f32 v220, v214, v220
  v_mul_f32 v221, v215, v221
  v_cvt_pk_bf16_f32 v216, v218, v219
  v_cvt_pk_bf16_f32 v217, v220, v221
  v_lshlrev_b32 v218, 16, v216
  v_and_b32 v219, 0xffff0000, v216
  v_lshlrev_b32 v220, 16, v217
  v_and_b32 v221, 0xffff0000, v217
  v_lshlrev_b32 v222, 16, v166
  v_and_b32 v223, 0xffff0000, v166
  v_lshlrev_b32 v224, 16, v167
  v_and_b32 v225, 0xffff0000, v167
  v_add_f32 v218, v218, v222
  v_add_f32 v219, v219, v223
  v_add_f32 v220, v220, v224
  v_add_f32 v221, v221, v225
  v_cvt_pk_bf16_f32 v232, v218, v219
  v_cvt_pk_bf16_f32 v233, v220, v221
  v_cmp_gt_u32 vcc, 50, v5
  s_nop 1
  s_and_saveexec_b64 s[62:63], vcc
  s_cbranch_execz K2_nost
  buffer_store_dwordx2 v[226:227], v7, s[24:27], s60 offen offset:0
  buffer_store_dwordx2 v[228:229], v7, s[24:27], s60 offen offset:16
  buffer_store_dwordx2 v[230:231], v7, s[24:27], s60 offen offset:32
  buffer_store_dwordx2 v[232:233], v7, s[24:27], s60 offen offset:48
K2_nost:
  s_mov_b64 exec, s[62:63]
  s_cmp_lg_u32 s36, 7
  s_cbranch_scc1 K2_END
  v_cmp_gt_u32 vcc, 50, v1
  s_nop 1
  s_and_saveexec_b64 s[62:63], vcc
  v_mul_u32_u24 v4, 528, v1
  v_add_u32 v4, 122752, v4
  ds_read_b128 v[240:243], v4
  v_add_u32 v5, s37, v1
  v_mul_u32_u24 v5, 6, v5
  buffer_load_ushort v244, v5, s[28:31], 0 offen
  buffer_load_ushort v245, v5, s[28:31], 0 offen offset:2
  buffer_load_ushort v246, v5, s[28:31], 0 offen offset:4
  s_mov_b32 s60, 3200000
  s_waitcnt vmcnt(0) lgkmcnt(0)
  v_lshlrev_b32 v244, 16, v244
  v_fmac_f32 v244, s61, v240
  v_cvt_pk_bf16_f32 v244, v244, v244
  buffer_store_short v244, v5, s[24:27], s60 offen offset:0
  v_lshlrev_b32 v245, 16, v245
  v_fmac_f32 v245, s61, v241
  v_cvt_pk_bf16_f32 v245, v245, v245
  buffer_store_short v245, v5, s[24:27], s60 offen offset:2
  v_lshlrev_b32 v246, 16, v246
  v_fmac_f32 v246, s61, v242
  v_cvt_pk_bf16_f32 v246, v246, v246
  buffer_store_short v246, v5, s[24:27], s60 offen offset:4
  s_mov_b64 exec, s[62:63]
  s_branch K2_END
K2_END:
K2_EXIT:
  s_endpgm
.section .rodata,"a"
.p2align 6
.amdhsa_kernel egnn_prep_kernel
  .amdhsa_next_free_vgpr 128
  .amdhsa_next_free_sgpr 102
  .amdhsa_accum_offset 128
  .amdhsa_group_segment_fixed_size 0
  .amdhsa_kernarg_size 88
  .amdhsa_user_sgpr_count 2
  .amdhsa_user_sgpr_kernarg_segment_ptr 1
  .amdhsa_system_sgpr_workgroup_id_x 1
.end_amdhsa_kernel
.p2align 6
.amdhsa_kernel standalone__cheap_equivariant_egnn__graph_kernel
  .amdhsa_next_free_vgpr 256
  .amdhsa_next_free_sgpr 102
  .amdhsa_accum_offset 256
  .amdhsa_group_segment_fixed_size 0
  .amdhsa_kernarg_size 88
  .amdhsa_user_sgpr_count 2
  .amdhsa_user_sgpr_kernarg_segment_ptr 1
  .amdhsa_system_sgpr_workgroup_id_x 1
.end_amdhsa_kernel
```
